```python
import torch

def _softmax(x, axis=-1):
    return torch.softmax(x, dim=axis)
def _gelu(x):
    return torch.nn.functional.gelu(x, approximate="tanh")
def _silu(x):
    return torch.nn.functional.silu(x)
def _sigmoid(x):
    return torch.sigmoid(x)
def _layernorm(x, axis=-1, eps=1e-5):
    m = x.mean(dim=axis, keepdim=True)
    v = x.var(dim=axis, keepdim=True, unbiased=False)
    return (x - m) / torch.sqrt(v + eps)
def _scatter_add(tgt, idx, src, axis=0):
    return tgt.clone().index_add_(axis, idx, src)
def _segment_sum(src, seg, n):
    out = torch.zeros((n,) + src.shape[1:], dtype=src.dtype)
    return out.index_add_(0, seg, src)
def _pad(x, pw):
    flat = tuple(v for pair in reversed(pw) for v in pair)
    return torch.nn.functional.pad(x, flat)

kernel_name = 'gated_mix__sliding_block__mixer_channel_mlp__prompt'

def setup_inputs():

    _w = (lambda a: (lambda t: t.to(torch.bfloat16) if t.is_floating_point() else t)(torch.as_tensor(a)))
    def _A_setup():
        B, S, D = 1, 2048, 512
        return {
            "x": _w((lambda *s: torch.randn(*s, dtype=torch.bfloat16) * 0.05)(B, S, D)),
            "wqkv": _w((lambda *s: torch.randn(*s, dtype=torch.bfloat16) * 0.8)(D, 3 * D)),
            "wo": _w((lambda *s: torch.randn(*s, dtype=torch.bfloat16) * 0.05)(D, D)),
        }
    _A_in = _A_setup()

    def _B_setup():
        B, S, D, F = 1, 2048, 512, 1376
        return {
            "x": _w((lambda *s: torch.randn(*s, dtype=torch.bfloat16) * 0.05)(B, S, D)),
            "w1": _w((lambda *s: torch.randn(*s, dtype=torch.bfloat16) * 3.2)(D, F) * (D ** -0.5)),
            "b1": _w((lambda *s: torch.randn(*s, dtype=torch.bfloat16) * 1.6)(F)),
            "w2": _w((lambda *s: torch.randn(*s, dtype=torch.bfloat16) * 0.2)(F, D) * (F ** -0.5)),
            "b2": _w((lambda *s: torch.randn(*s, dtype=torch.bfloat16) * 0.2)(D)),
        }
    _B_in = _B_setup()

    return {
        "A_x": _A_in["x"],
        "A_wqkv": _A_in["wqkv"],
        "A_wo": _A_in["wo"],
        "B_x": _B_in["x"],
        "B_w1": _B_in["w1"],
        "B_b1": _B_in["b1"],
        "B_w2": _B_in["w2"],
        "B_b2": _B_in["b2"],
        "gate_w": _w((lambda *s: torch.randn(*s, dtype=torch.bfloat16) * 0.05)(512) * 16.0),
    }

def reference(A_x, A_wqkv, A_wo, B_x, B_w1, B_b1, B_w2, B_b2, gate_w):
    def _A_ref(x, wqkv, wo):
        B, S, D = x.shape
        H = 32; Dh = D // H; W = 256
        qkv = (lambda x, *d: x.permute(*d))((x @ wqkv).reshape(B, S, 3, H, Dh), 2, 0, 3, 1, 4)
        q, k, v = qkv[0], qkv[1], qkv[2]
        scores = torch.einsum("bhqd,bhkd->bhqk", q, k) * (Dh ** -0.5)
        idx = torch.arange(S)
        mask = (idx[:, None] - idx[None, :] >= 0) & (idx[:, None] - idx[None, :] < W)
        scores = torch.where(mask[None, None], scores, -1e9)
        p = _softmax(scores, axis=-1)
        o = torch.einsum("bhqk,bhkd->bhqd", p, v)
        return (lambda x, *d: x.permute(*d))(o, 0, 2, 1, 3).reshape(B, S, D) @ wo

    def _B_ref(x, w1, b1, w2, b2):
        y = _layernorm(x, axis=-1)
        h = _gelu(torch.einsum("bsd,df->bsf", y, w1) + b1)
        return torch.einsum("bsf,fd->bsd", h, w2) + b2

    x = A_x
    g = _sigmoid((x * gate_w).sum(-1, keepdims=True))
    a = _A_ref(x, A_wqkv, A_wo)
    b = _B_ref(x, B_w1, B_b1, B_w2, B_b2)
    return g * a + (1 - g) * b
```

```asm
; @launch grid=(256,1,1) block=(256,1,1) lds=163840
.amdgcn_target "amdgcn-amd-amdhsa--gfx950"
.text
.globl gated_mix__sliding_block__mixer_channel_mlp__prompt_kernel
.p2align 8
.type gated_mix__sliding_block__mixer_channel_mlp__prompt_kernel,@function
gated_mix__sliding_block__mixer_channel_mlp__prompt_kernel:
    s_cmp_ge_u32 s2, 256
    s_cbranch_scc1 L_end
    s_load_dwordx16 s[64:79], s[0:1], 0
    s_load_dwordx8 s[80:87], s[0:1], 64
    s_getpc_b64 s[94:95]
    s_lshr_b32 s56, s2, 3
    s_lshl_b32 s56, s56, 4
    v_lshrrev_b32_e64 v104, 4, v0
    v_add_lshl_u32 v104, v104, s56, 7
    v_min_u32 v104, L_code_end-gated_mix__sliding_block__mixer_channel_mlp__prompt_kernel-1024, v104
    global_load_dword a248, v104, s[94:95]
    v_lshrrev_b32 v1, 6, v0
    v_and_b32_e64 v0, 63, v0
    v_readfirstlane_b32 s3, v1
    s_bfe_u32 s4, s2, 0x20001
    s_bfe_u32 s56, s2, 0x20003
    s_lshl2_add_u32 s4, s4, s56
    s_and_b32 s5, s2, 1
    s_lshr_b32 s55, s2, 5
    s_lshl3_add_u32 s5, s5, s55
    s_lshl1_add_u32 s6, s56, s5
    s_and_b32 s6, s6, 7
    s_mul_i32 s7, s3, 40960
    s_lshl2_add_u32 s97, s4, s3
    s_lshl_b32 s98, s97, 15
    s_lshl_b32 s88, s6, 7
    s_add_u32 s88, s88, s98
    v_lshrrev_b32 v96, 3, v0
    v_and_b32 v97, 7, v0
    v_lshrrev_b32 v98, 4, v0
    v_xor_b32 v99, v97, v98
    v_lshlrev_b32_e64 v99, 4, v99
    v_lshl_add_u32 v1, v96, 10, v99
    v_xor_b32_e64 v2, 64, v1
    v_add_u32 v3, 14336, v1
    v_add_u32 v4, 21504, v2
    v_add_u32 v2, 7168, v2
    s_mov_b32 s10, 2097152
    s_mov_b32 s11, 0x20000
    s_lshl_b32 s62, s3, 4
    s_lshl_b32 s57, s5, 7
    s_add_u32 s57, s57, 1024
    v_and_b32 v98, 1, v98
    v_lshlrev_b32 v98, 2, v98
    v_xor_b32 v99, v97, v98
    v_lshlrev_b32 v103, 4, v99
    v_mul_u32_u24 v9, 3072, v96
    v_add3_u32 v9, v9, v103, s57
    v_add_u32 v10, 23552, v9
    s_lshl_b32 s54, s6, 6
    s_add_u32 s54, s54, s62
    s_mul_i32 s89, s54, 3072
    v_add_u32 v98, s6, v96
    v_and_b32 v98, 7, v98
    v_lshl_add_u32 v98, v98, 3, v97
    v_lshlrev_b32_e64 v102, 4, v98
    s_add_u32 s54, s6, 1
    s_and_b32 s54, s54, 7
    s_lshl_b32 s90, s54, 7
    s_add_u32 s90, s90, s98
    s_lshl_b32 s54, s54, 6
    s_add_u32 s54, s54, s62
    s_mul_i32 s91, s54, 3072
    s_waitcnt lgkmcnt(0)
    s_mov_b32 s8, s64
    s_mov_b32 s9, s65
    s_add_u32 m0, s7, 0
    s_nop 0
    buffer_load_dwordx4 v1, s[8:11], s88 offen offset:0 lds
    buffer_load_dwordx4 v2, s[8:11], s88 offen offset:1024 lds
    buffer_load_dwordx4 v3, s[8:11], s88 offen offset:2048 lds
    buffer_load_dwordx4 v4, s[8:11], s88 offen offset:3072 lds
    s_mov_b32 s12, s66
    s_mov_b32 s13, s67
    s_mov_b32 s14, 0x00180000
    s_mov_b32 s15, 0x20000
    s_add_u32 m0, s7, 16384
    s_nop 0
    buffer_load_dwordx4 v9, s[12:15], s89 offen offset:0 lds
    buffer_load_dwordx4 v10, s[12:15], s89 offen offset:1024 lds
    s_mov_b32 s48, s80
    s_mov_b32 s49, s81
    s_mov_b32 s50, 0x00000400
    s_mov_b32 s51, 0x20000
    s_mov_b32 m0, 38912
    s_mov_b32 s28, s86
    s_mov_b32 s29, s87
    s_mov_b32 s30, 0x03000000
    s_mov_b32 s31, 0x20000
    buffer_load_dwordx4 v102, s[48:51], 0 offen lds
    s_or_b32 s54, s2, s3
    s_cmp_lg_u32 s54, 0
    s_cbranch_scc1 L_nonon0
    buffer_load_dwordx2 v[106:107], off, s[28:31], 0 sc1
L_nonon0:
    s_add_u32 m0, s7, 18432
    s_nop 0
    buffer_load_dwordx4 v9, s[12:15], s91 offen offset:0 lds
    buffer_load_dwordx4 v10, s[12:15], s91 offen offset:1024 lds
    s_add_u32 m0, s7, 4096
    s_nop 0
    buffer_load_dwordx4 v1, s[8:11], s90 offen offset:0 lds
    buffer_load_dwordx4 v2, s[8:11], s90 offen offset:1024 lds
    buffer_load_dwordx4 v3, s[8:11], s90 offen offset:2048 lds
    buffer_load_dwordx4 v4, s[8:11], s90 offen offset:3072 lds
    s_mov_b32 s16, s72
    s_mov_b32 s17, s73
    s_mov_b32 s18, 0x00158000
    s_mov_b32 s19, 0x20000
    s_mov_b32 s20, s76
    s_mov_b32 s21, s77
    s_mov_b32 s22, 0x00158000
    s_mov_b32 s23, 0x20000
    s_mov_b32 s24, s68
    s_mov_b32 s25, s69
    s_mov_b32 s26, 0x00080000
    s_mov_b32 s27, 0x20000
    s_mov_b32 s44, s82
    s_mov_b32 s45, s83
    s_mov_b32 s46, 0x00200000
    s_mov_b32 s47, 0x20000
    s_lshl_b32 s54, s5, 18
    s_add_u32 s54, s54, 1048576
    s_add_u32 s32, s86, s54
    s_addc_u32 s33, s87, 0
    s_mov_b32 s34, 0x00040000
    s_mov_b32 s35, 0x20000
    s_lshl_b32 s54, s4, 19
    s_add_u32 s54, s54, 8388608
    s_lshr_b32 s55, s3, 1
    s_mul_i32 s55, s55, 180224
    s_add_u32 s55, s55, s54
    s_add_u32 s36, s86, s55
    s_addc_u32 s37, s87, 0
    s_mov_b32 s38, 0x0002b000
    s_mov_b32 s39, 0x20000
    s_add_u32 s54, s54, 360448
    s_add_u32 s40, s86, s54
    s_addc_u32 s41, s87, 0
    s_mov_b32 s42, 0x00020000
    s_mov_b32 s43, 0x20000
    s_mov_b64 s[88:89], s[74:75]
    s_mov_b32 s90, 2752
    s_mov_b32 s91, 0x20000
    s_and_b32 s54, s5, 7
    s_lshr_b32 s55, s5, 3
    s_mul_i32 s96, s55, 7
    s_add_u32 s96, s96, s54
    s_add_u32 s56, s55, 14
    s_lshl_b32 s55, s55, 2
    s_sub_u32 s55, 4, s55
    s_cmp_eq_u32 s54, 7
    s_cselect_b32 s96, s56, s96
    s_cselect_b32 s52, s55, 12
    s_mul_i32 s63, s96, 192
    s_mov_b64 s[92:93], s[78:79]
    s_mov_b32 s94, 0x400
    s_mov_b32 s95, 0x20000
    s_mov_b64 s[0:1], s[84:85]
    s_and_b32 s54, s5, 7
    s_lshl_b32 s54, s54, 19
    s_lshl_b32 s55, s97, 12
    s_add_u32 s54, s54, s55
    s_lshr_b32 s55, s5, 3
    s_lshl_b32 s55, s55, 11
    s_add_u32 s54, s54, s55
    s_add_u32 s59, s54, 1048576
    s_mul_i32 s60, s96, 12288
    s_and_b32 s54, s3, 1
    s_lshl_b32 s54, s54, 10
    s_add_u32 s60, s60, s54
    s_lshl_b32 s54, s4, 4
    s_add_u32 s54, s54, s5
    s_lshl_b32 s54, s54, 2
    s_add_u32 s54, s54, s3
    s_lshl_b32 s54, s54, 3
    s_add_u32 s58, s54, 4096
    s_lshr_b32 s57, s5, 1
    s_lshl_b32 s57, s57, 7
    s_mul_i32 s61, s3, 360448
    s_add_u32 s61, s61, s57
    s_mul_i32 s99, s3, 131072
    s_add_u32 s99, s99, s57
    s_sub_u32 s97, s97, 8
    s_add_u32 s54, s6, 0
    s_and_b32 s54, s54, 7
    s_lshl_b32 s64, s54, 7
    s_add_u32 s64, s64, s98
    s_lshl_b32 s54, s54, 6
    s_add_u32 s54, s54, s62
    s_mul_i32 s72, s54, 3072
    s_mul_i32 s80, s54, 2752
    s_add_u32 s54, s6, 1
    s_and_b32 s54, s54, 7
    s_lshl_b32 s65, s54, 7
    s_add_u32 s65, s65, s98
    s_lshl_b32 s54, s54, 6
    s_add_u32 s54, s54, s62
    s_mul_i32 s73, s54, 3072
    s_mul_i32 s81, s54, 2752
    s_add_u32 s54, s6, 2
    s_and_b32 s54, s54, 7
    s_lshl_b32 s66, s54, 7
    s_add_u32 s66, s66, s98
    s_lshl_b32 s54, s54, 6
    s_add_u32 s54, s54, s62
    s_mul_i32 s74, s54, 3072
    s_mul_i32 s82, s54, 2752
    s_add_u32 s54, s6, 3
    s_and_b32 s54, s54, 7
    s_lshl_b32 s67, s54, 7
    s_add_u32 s67, s67, s98
    s_lshl_b32 s54, s54, 6
    s_add_u32 s54, s54, s62
    s_mul_i32 s75, s54, 3072
    s_mul_i32 s83, s54, 2752
    s_add_u32 s54, s6, 4
    s_and_b32 s54, s54, 7
    s_lshl_b32 s68, s54, 7
    s_add_u32 s68, s68, s98
    s_lshl_b32 s54, s54, 6
    s_add_u32 s54, s54, s62
    s_mul_i32 s76, s54, 3072
    s_mul_i32 s84, s54, 2752
    s_add_u32 s54, s6, 5
    s_and_b32 s54, s54, 7
    s_lshl_b32 s69, s54, 7
    s_add_u32 s69, s69, s98
    s_lshl_b32 s54, s54, 6
    s_add_u32 s54, s54, s62
    s_mul_i32 s77, s54, 3072
    s_mul_i32 s85, s54, 2752
    s_add_u32 s54, s6, 6
    s_and_b32 s54, s54, 7
    s_lshl_b32 s70, s54, 7
    s_add_u32 s70, s70, s98
    s_lshl_b32 s54, s54, 6
    s_add_u32 s54, s54, s62
    s_mul_i32 s78, s54, 3072
    s_mul_i32 s86, s54, 2752
    s_add_u32 s54, s6, 7
    s_and_b32 s54, s54, 7
    s_lshl_b32 s71, s54, 7
    s_add_u32 s71, s71, s98
    s_lshl_b32 s54, s54, 6
    s_add_u32 s54, s54, s62
    s_mul_i32 s79, s54, 3072
    s_mul_i32 s87, s54, 2752
    v_and_b32 v100, 31, v0
    v_lshrrev_b32 v97, 5, v0
    v_bfe_u32 v98, v0, 1, 3
    v_xor_b32 v98, v97, v98
    v_lshlrev_b32 v98, 4, v98
    v_lshl_add_u32 v98, v100, 7, v98
    v_add_u32 v5, s7, v98
    v_xor_b32 v6, 32, v5
    v_xor_b32_e64 v7, 64, v5
    v_xor_b32 v8, 96, v5
    v_lshlrev_b32 v23, 4, v97
    v_lshlrev_b32 v24, 4, v0
    v_bfe_u32 v96, v0, 2, 2
    v_lshl_add_u32 v96, v97, 3, v96
    v_bfe_u32 v98, v0, 4, 1
    v_lshlrev_b32_e64 v98, 1, v98
    v_bfe_u32 v101, v0, 1, 1
    v_add_u32_e64 v98, v98, v101
    v_bfe_u32 v101, v0, 3, 1
    v_lshlrev_b32 v101, 2, v101
    v_xor_b32 v101, v98, v101
    v_lshlrev_b32_e64 v101, 4, v101
    v_lshl_add_u32 v101, v96, 7, v101
    v_and_b32_e64 v13, 1, v0
    v_lshl_add_u32 v13, v13, 3, v101
    v_xor_b32_e64 v16, 64, v13
    v_add_u32 v14, 0x10000, v13
    v_add_u32 v15, 0x20000, v13
    v_add_u32 v17, 0x10000, v16
    v_add_u32 v18, 0x20000, v16
    v_bfe_u32 v98, v0, 4, 1
    v_lshlrev_b32 v98, 5, v98
    v_and_b32 v99, 3, v0
    v_lshl_add_u32 v98, v99, 3, v98
    v_lshl_add_u32 v19, v96, 6, v98
    v_add_u32 v20, 0x10000, v19
    v_add_u32 v21, 0x20000, v19
    v_mul_u32_u24 v96, 192, v96
    v_add_u32_e64 v83, v96, v98
    v_add_u32 v84, 0x10000, v83
    v_add_u32 v85, 0x20000, v83
    v_add_u32 v22, s7, v83
    s_lshl_b32 s55, s5, 6
    v_lshrrev_b32 v96, 2, v0
    v_lshlrev_b32 v98, 4, v99
    v_mul_u32_u24 v12, 3072, v96
    v_add3_u32 v12, v12, v98, s55
    v_add_u32_e64 v97, 0, v0
    v_mul_u32_u24 v96, 171, v97
    v_lshrrev_b32 v96, 11, v96
    v_mul_u32_u24 v98, 12, v96
    v_sub_u32 v97, v97, v98
    v_cmp_gt_u32 vcc, s52, v97
    v_mul_u32_u24 v96, 2560, v96
    v_add3_u32 v96, v96, v24, s63
    v_bfrev_b32 v97, -2
    v_cndmask_b32 v80, v97, v96, vcc
    v_add_u32_e64 v97, 64, v0
    v_mul_u32_u24 v96, 171, v97
    v_lshrrev_b32 v96, 11, v96
    v_mul_u32_u24 v98, 12, v96
    v_sub_u32 v97, v97, v98
    v_cmp_gt_u32 vcc, s52, v97
    v_mul_u32_u24 v96, 2560, v96
    v_add3_u32 v96, v96, v24, s63
    v_bfrev_b32 v97, -2
    v_cndmask_b32 v81, v97, v96, vcc
    v_add_u32 v97, 128, v0
    v_mul_u32_u24 v96, 171, v97
    v_lshrrev_b32 v96, 11, v96
    v_mul_u32_u24 v98, 12, v96
    v_sub_u32 v97, v97, v98
    v_cmp_gt_u32 vcc, s52, v97
    v_mul_u32_u24 v96, 2560, v96
    v_add3_u32 v96, v96, v24, s63
    v_bfrev_b32 v97, -2
    v_cndmask_b32 v82, v97, v96, vcc
    v_mov_b32 v26, 0
    v_mov_b32 v30, 0
    v_mov_b32_e64 v31, 0
    s_mov_b32 s48, s0
    s_mov_b32 s49, s1
    s_mov_b32 s50, 0x00000100
    s_mov_b32 s51, 0x20000
    v_lshlrev_b32 v88, 2, v0
    v_and_b32 v96, 15, v0
    v_bfe_u32 v97, v0, 4, 1
    v_cmp_eq_u32 vcc, v96, v97
    v_mov_b32 v98, 81984
    v_mov_b32 v99, 40992
    v_cndmask_b32 v98, v98, v99, vcc
    v_mov_b32 v100, 0x3f803f80
    v_cndmask_b32 v92, 0, v100, vcc
    v_add_u32 v97, 2, v97
    v_cmp_eq_u32 vcc, v96, v97
    v_mov_b32 v101, v100
    v_mov_b64 v[102:103], v[100:101]
    v_cndmask_b32 v23, v98, v23, vcc
    v_mov_b64 v[108:109], 0
    v_mov_b64 v[110:111], 0
    v_add_u32 v98, 79904, v24
    ds_write_b128 v98, v[100:103]
    ds_write_b128 v98, v[108:111] offset:40992
    v_mov_b32 v93, v92
    v_mov_b32 v94, v92
    v_mov_b32 v95, v92
    s_lshr_b32 s0, s2, 3
    s_lshl_b32 s0, s0, 2
    s_add_u32 s0, s0, s3
    s_lshr_b32 s54, s5, 3
    s_lshl_b32 s54, s54, 9
    s_mul_i32 s1, s0, 11264
    s_add_u32 s1, s1, s54
    s_lshl_b32 s0, s0, 12
    s_add_u32 s0, s0, s54
    s_or_b32 s54, s2, s3
    s_cmp_lg_u32 s54, 0
    s_cbranch_scc1 L_nonon1
    s_waitcnt vmcnt(6)
    v_add_co_u32 v106, vcc, 0x7f4a7c16, v106
    v_mov_b32 v112, 0x9e3779b9
    s_nop 0
    v_addc_co_u32 v107, vcc, v112, v107, vcc
    v_or_b32_e64 v106, 1, v106
    s_mov_b64 exec, 1
    buffer_store_dwordx2 v[106:107], off, s[28:31], 0 sc0 sc1
    buffer_store_dwordx2 v[106:107], off, s[48:51], 0 sc0 sc1
    s_mov_b64 exec, -1
L_nonon1:
    s_cmp_ge_u32 s5, 8
    s_cbranch_scc1 L_kv_v
    s_add_u32 m0, s7, 8192
    s_nop 0
    buffer_load_dwordx4 v1, s[8:11], s66 offen offset:0 lds
    buffer_load_dwordx4 v2, s[8:11], s66 offen offset:1024 lds
    buffer_load_dwordx4 v3, s[8:11], s66 offen offset:2048 lds
    buffer_load_dwordx4 v4, s[8:11], s66 offen offset:3072 lds
    s_add_u32 m0, s7, 20480
    s_nop 0
    buffer_load_dwordx4 v9, s[12:15], s74 offen offset:0 lds
    buffer_load_dwordx4 v10, s[12:15], s74 offen offset:1024 lds
    s_waitcnt vmcnt(12)
    s_waitcnt lgkmcnt(0)
    s_barrier
    ds_read_b128 v[128:131], v5 offset:0
    ds_read_b64_tr_b16 a[0:1], v13 offset:16384
    ds_read_b64_tr_b16 a[2:3], v13 offset:16896
    ds_read_b64_tr_b16 a[4:5], v16 offset:16384
    ds_read_b64_tr_b16 a[6:7], v16 offset:16896
    ds_read_b128 a[32:35], v23 offset:38912
    ds_read_b128 v[132:135], v6 offset:0
    ds_read_b64_tr_b16 a[8:9], v13 offset:57344
    ds_read_b64_tr_b16 a[10:11], v13 offset:57856
    ds_read_b64_tr_b16 a[12:13], v16 offset:57344
    ds_read_b64_tr_b16 a[14:15], v16 offset:57856
    ds_read_b128 a[36:39], v23 offset:38944
    s_waitcnt lgkmcnt(9)
    v_mfma_f32_32x32x16_bf16 v[32:47], a[0:3], v[128:131], 0
    ds_read_b128 v[136:139], v7 offset:0
    ds_read_b64_tr_b16 a[16:17], v14 offset:32768
    ds_read_b64_tr_b16 a[18:19], v14 offset:33280
    s_waitcnt lgkmcnt(10)
    v_mfma_f32_32x32x16_bf16 v[48:63], a[4:7], v[128:131], 0
    ds_read_b64_tr_b16 a[20:21], v17 offset:32768
    ds_read_b64_tr_b16 a[22:23], v17 offset:33280
    ds_read_b128 a[40:43], v23 offset:38976
    s_add_u32 m0, s7, 22528
    s_nop 0
    buffer_load_dwordx4 v9, s[12:15], s75 offen offset:0 lds
    s_waitcnt lgkmcnt(12)
    v_mfma_f32_16x16x32_bf16 v[96:99], v[128:131], a[32:35], 0
    s_waitcnt lgkmcnt(9)
    v_mfma_f32_32x32x16_bf16 v[32:47], a[8:11], v[132:135], v[32:47]
    ds_read_b128 v[140:143], v8 offset:0
    ds_read_b64_tr_b16 a[24:25], v15 offset:8192
    ds_read_b64_tr_b16 a[26:27], v15 offset:8704
    buffer_load_dwordx4 v10, s[12:15], s75 offen offset:1024 lds
    s_waitcnt lgkmcnt(10)
    v_mfma_f32_32x32x16_bf16 v[48:63], a[12:15], v[132:135], v[48:63]
    ds_read_b64_tr_b16 a[28:29], v18 offset:8192
    ds_read_b64_tr_b16 a[30:31], v18 offset:8704
    ds_read_b128 a[44:47], v23 offset:39008
    s_add_u32 m0, s7, 12288
    s_nop 0
    buffer_load_dwordx4 v1, s[8:11], s67 offen offset:0 lds
    s_waitcnt lgkmcnt(12)
    v_mfma_f32_16x16x32_bf16 v[96:99], v[132:135], a[36:39], v[96:99]
    s_waitcnt lgkmcnt(9)
    v_mfma_f32_32x32x16_bf16 v[32:47], a[16:19], v[136:139], v[32:47]
    s_waitcnt vmcnt(9)
    s_barrier
    ds_read_b128 v[144:147], v5 offset:4096
    ds_read_b64_tr_b16 a[0:1], v13 offset:18432
    ds_read_b64_tr_b16 a[2:3], v13 offset:18944
    s_waitcnt lgkmcnt(10)
    v_mfma_f32_32x32x16_bf16 v[48:63], a[20:23], v[136:139], v[48:63]
    ds_read_b64_tr_b16 a[4:5], v16 offset:18432
    ds_read_b64_tr_b16 a[6:7], v16 offset:18944
    ds_read_b128 a[32:35], v23 offset:39040
    buffer_load_dwordx4 v2, s[8:11], s67 offen offset:1024 lds
    s_waitcnt lgkmcnt(12)
    v_mfma_f32_16x16x32_bf16 v[96:99], v[136:139], a[40:43], v[96:99]
    s_waitcnt lgkmcnt(9)
    v_mfma_f32_32x32x16_bf16 v[32:47], a[24:27], v[140:143], v[32:47]
    ds_read_b128 v[148:151], v6 offset:4096
    ds_read_b64_tr_b16 a[8:9], v13 offset:59392
    ds_read_b64_tr_b16 a[10:11], v13 offset:59904
    buffer_load_dwordx4 v3, s[8:11], s67 offen offset:2048 lds
    s_waitcnt lgkmcnt(10)
    v_mfma_f32_32x32x16_bf16 v[48:63], a[28:31], v[140:143], v[48:63]
    ds_read_b64_tr_b16 a[12:13], v16 offset:59392
    ds_read_b64_tr_b16 a[14:15], v16 offset:59904
    ds_read_b128 a[36:39], v23 offset:39072
    buffer_load_dwordx4 v4, s[8:11], s67 offen offset:3072 lds
    s_waitcnt lgkmcnt(12)
    v_mfma_f32_16x16x32_bf16 v[96:99], v[140:143], a[44:47], v[96:99]
    v_dot2c_f32_bf16 v26, v128, v128
    v_dot2c_f32_bf16 v26, v129, v129
    v_dot2c_f32_bf16 v26, v130, v130
    v_dot2c_f32_bf16 v26, v131, v131
    v_dot2c_f32_bf16 v26, v132, v132
    v_dot2c_f32_bf16 v26, v133, v133
    v_dot2c_f32_bf16 v26, v134, v134
    v_dot2c_f32_bf16 v26, v135, v135
    v_dot2c_f32_bf16 v26, v136, v136
    v_dot2c_f32_bf16 v26, v137, v137
    v_dot2c_f32_bf16 v26, v138, v138
    v_dot2c_f32_bf16 v26, v139, v139
    v_dot2c_f32_bf16 v26, v140, v140
    v_dot2c_f32_bf16 v26, v141, v141
    v_dot2c_f32_bf16 v26, v142, v142
    v_dot2c_f32_bf16 v26, v143, v143
    s_waitcnt lgkmcnt(9)
    v_mfma_f32_32x32x16_bf16 v[32:47], a[0:3], v[144:147], v[32:47]
    ds_read_b128 v[152:155], v7 offset:4096
    ds_read_b64_tr_b16 a[16:17], v14 offset:34816
    ds_read_b64_tr_b16 a[18:19], v14 offset:35328
    s_add_u32 m0, s7, 24576
    s_nop 0
    buffer_load_dwordx4 v9, s[12:15], s76 offen offset:0 lds
    s_waitcnt lgkmcnt(10)
    v_mfma_f32_32x32x16_bf16 v[48:63], a[4:7], v[144:147], v[48:63]
    ds_read_b64_tr_b16 a[20:21], v17 offset:34816
    ds_read_b64_tr_b16 a[22:23], v17 offset:35328
    ds_read_b128 a[40:43], v23 offset:39104
    buffer_load_dwordx4 v10, s[12:15], s76 offen offset:1024 lds
    s_waitcnt lgkmcnt(12)
    v_mfma_f32_16x16x32_bf16 v[96:99], v[144:147], a[32:35], v[96:99]
    s_waitcnt lgkmcnt(9)
    v_mfma_f32_32x32x16_bf16 v[32:47], a[8:11], v[148:151], v[32:47]
    ds_read_b128 v[156:159], v8 offset:4096
    ds_read_b64_tr_b16 a[24:25], v15 offset:10240
    ds_read_b64_tr_b16 a[26:27], v15 offset:10752
    s_add_u32 m0, s7, 0
    s_nop 0
    buffer_load_dwordx4 v1, s[8:11], s68 offen offset:0 lds
    s_waitcnt lgkmcnt(10)
    v_mfma_f32_32x32x16_bf16 v[48:63], a[12:15], v[148:151], v[48:63]
    ds_read_b64_tr_b16 a[28:29], v18 offset:10240
    ds_read_b64_tr_b16 a[30:31], v18 offset:10752
    ds_read_b128 a[44:47], v23 offset:39136
    buffer_load_dwordx4 v2, s[8:11], s68 offen offset:1024 lds
    s_waitcnt lgkmcnt(12)
    v_mfma_f32_16x16x32_bf16 v[96:99], v[148:151], a[36:39], v[96:99]
    s_waitcnt lgkmcnt(9)
    v_mfma_f32_32x32x16_bf16 v[32:47], a[16:19], v[152:155], v[32:47]
    s_waitcnt vmcnt(10)
    s_barrier
    ds_read_b128 v[160:163], v5 offset:8192
    ds_read_b64_tr_b16 a[0:1], v13 offset:20480
    ds_read_b64_tr_b16 a[2:3], v13 offset:20992
    s_waitcnt lgkmcnt(10)
    v_mfma_f32_32x32x16_bf16 v[48:63], a[20:23], v[152:155], v[48:63]
    ds_read_b64_tr_b16 a[4:5], v16 offset:20480
    ds_read_b64_tr_b16 a[6:7], v16 offset:20992
    ds_read_b128 a[32:35], v23 offset:39168
    buffer_load_dwordx4 v3, s[8:11], s68 offen offset:2048 lds
    s_waitcnt lgkmcnt(12)
    v_mfma_f32_16x16x32_bf16 v[96:99], v[152:155], a[40:43], v[96:99]
    s_waitcnt lgkmcnt(9)
    v_mfma_f32_32x32x16_bf16 v[32:47], a[24:27], v[156:159], v[32:47]
    ds_read_b128 v[164:167], v6 offset:8192
    ds_read_b64_tr_b16 a[8:9], v13 offset:61440
    ds_read_b64_tr_b16 a[10:11], v13 offset:61952
    buffer_load_dwordx4 v4, s[8:11], s68 offen offset:3072 lds
    s_waitcnt lgkmcnt(10)
    v_mfma_f32_32x32x16_bf16 v[48:63], a[28:31], v[156:159], v[48:63]
    ds_read_b64_tr_b16 a[12:13], v16 offset:61440
    ds_read_b64_tr_b16 a[14:15], v16 offset:61952
    ds_read_b128 a[36:39], v23 offset:39200
    s_add_u32 m0, s7, 26624
    s_nop 0
    buffer_load_dwordx4 v9, s[12:15], s77 offen offset:0 lds
    s_waitcnt lgkmcnt(12)
    v_mfma_f32_16x16x32_bf16 v[96:99], v[156:159], a[44:47], v[96:99]
    v_dot2c_f32_bf16 v26, v144, v144
    v_dot2c_f32_bf16 v26, v145, v145
    v_dot2c_f32_bf16 v26, v146, v146
    v_dot2c_f32_bf16 v26, v147, v147
    v_dot2c_f32_bf16 v26, v148, v148
    v_dot2c_f32_bf16 v26, v149, v149
    v_dot2c_f32_bf16 v26, v150, v150
    v_dot2c_f32_bf16 v26, v151, v151
    v_dot2c_f32_bf16 v26, v152, v152
    v_dot2c_f32_bf16 v26, v153, v153
    v_dot2c_f32_bf16 v26, v154, v154
    v_dot2c_f32_bf16 v26, v155, v155
    v_dot2c_f32_bf16 v26, v156, v156
    v_dot2c_f32_bf16 v26, v157, v157
    v_dot2c_f32_bf16 v26, v158, v158
    v_dot2c_f32_bf16 v26, v159, v159
    s_waitcnt lgkmcnt(9)
    v_mfma_f32_32x32x16_bf16 v[32:47], a[0:3], v[160:163], v[32:47]
    ds_read_b128 v[168:171], v7 offset:8192
    ds_read_b64_tr_b16 a[16:17], v14 offset:36864
    ds_read_b64_tr_b16 a[18:19], v14 offset:37376
    buffer_load_dwordx4 v10, s[12:15], s77 offen offset:1024 lds
    s_waitcnt lgkmcnt(10)
    v_mfma_f32_32x32x16_bf16 v[48:63], a[4:7], v[160:163], v[48:63]
    ds_read_b64_tr_b16 a[20:21], v17 offset:36864
    ds_read_b64_tr_b16 a[22:23], v17 offset:37376
    ds_read_b128 a[40:43], v23 offset:39232
    s_add_u32 m0, s7, 4096
    s_nop 0
    buffer_load_dwordx4 v1, s[8:11], s69 offen offset:0 lds
    s_waitcnt lgkmcnt(12)
    v_mfma_f32_16x16x32_bf16 v[96:99], v[160:163], a[32:35], v[96:99]
    s_waitcnt lgkmcnt(9)
    v_mfma_f32_32x32x16_bf16 v[32:47], a[8:11], v[164:167], v[32:47]
    ds_read_b128 v[172:175], v8 offset:8192
    ds_read_b64_tr_b16 a[24:25], v15 offset:12288
    ds_read_b64_tr_b16 a[26:27], v15 offset:12800
    buffer_load_dwordx4 v2, s[8:11], s69 offen offset:1024 lds
    s_waitcnt lgkmcnt(10)
    v_mfma_f32_32x32x16_bf16 v[48:63], a[12:15], v[164:167], v[48:63]
    ds_read_b64_tr_b16 a[28:29], v18 offset:12288
    ds_read_b64_tr_b16 a[30:31], v18 offset:12800
    ds_read_b128 a[44:47], v23 offset:39264
    buffer_load_dwordx4 v3, s[8:11], s69 offen offset:2048 lds
    s_waitcnt lgkmcnt(12)
    v_mfma_f32_16x16x32_bf16 v[96:99], v[164:167], a[36:39], v[96:99]
    s_waitcnt lgkmcnt(9)
    v_mfma_f32_32x32x16_bf16 v[32:47], a[16:19], v[168:171], v[32:47]
    s_waitcnt vmcnt(11)
    s_barrier
    ds_read_b128 v[176:179], v5 offset:12288
    ds_read_b64_tr_b16 a[0:1], v13 offset:22528
    ds_read_b64_tr_b16 a[2:3], v13 offset:23040
    s_waitcnt lgkmcnt(10)
    v_mfma_f32_32x32x16_bf16 v[48:63], a[20:23], v[168:171], v[48:63]
    ds_read_b64_tr_b16 a[4:5], v16 offset:22528
    ds_read_b64_tr_b16 a[6:7], v16 offset:23040
    ds_read_b128 a[32:35], v23 offset:39296
    buffer_load_dwordx4 v4, s[8:11], s69 offen offset:3072 lds
    s_waitcnt lgkmcnt(12)
    v_mfma_f32_16x16x32_bf16 v[96:99], v[168:171], a[40:43], v[96:99]
    s_waitcnt lgkmcnt(9)
    v_mfma_f32_32x32x16_bf16 v[32:47], a[24:27], v[172:175], v[32:47]
    ds_read_b128 v[180:183], v6 offset:12288
    ds_read_b64_tr_b16 a[8:9], v13 offset:63488
    ds_read_b64_tr_b16 a[10:11], v13 offset:64000
    s_add_u32 m0, s7, 28672
    s_nop 0
    buffer_load_dwordx4 v9, s[12:15], s78 offen offset:0 lds
    s_waitcnt lgkmcnt(10)
    v_mfma_f32_32x32x16_bf16 v[48:63], a[28:31], v[172:175], v[48:63]
    ds_read_b64_tr_b16 a[12:13], v16 offset:63488
    ds_read_b64_tr_b16 a[14:15], v16 offset:64000
    ds_read_b128 a[36:39], v23 offset:39328
    buffer_load_dwordx4 v10, s[12:15], s78 offen offset:1024 lds
    s_waitcnt lgkmcnt(12)
    v_mfma_f32_16x16x32_bf16 v[96:99], v[172:175], a[44:47], v[96:99]
    v_dot2c_f32_bf16 v26, v160, v160
    v_dot2c_f32_bf16 v26, v161, v161
    v_dot2c_f32_bf16 v26, v162, v162
    v_dot2c_f32_bf16 v26, v163, v163
    v_dot2c_f32_bf16 v26, v164, v164
    v_dot2c_f32_bf16 v26, v165, v165
    v_dot2c_f32_bf16 v26, v166, v166
    v_dot2c_f32_bf16 v26, v167, v167
    v_dot2c_f32_bf16 v26, v168, v168
    v_dot2c_f32_bf16 v26, v169, v169
    v_dot2c_f32_bf16 v26, v170, v170
    v_dot2c_f32_bf16 v26, v171, v171
    v_dot2c_f32_bf16 v26, v172, v172
    v_dot2c_f32_bf16 v26, v173, v173
    v_dot2c_f32_bf16 v26, v174, v174
    v_dot2c_f32_bf16 v26, v175, v175
    s_waitcnt lgkmcnt(9)
    v_mfma_f32_32x32x16_bf16 v[32:47], a[0:3], v[176:179], v[32:47]
    ds_read_b128 v[184:187], v7 offset:12288
    ds_read_b64_tr_b16 a[16:17], v14 offset:38912
    ds_read_b64_tr_b16 a[18:19], v14 offset:39424
    s_add_u32 m0, s7, 8192
    s_nop 0
    buffer_load_dwordx4 v1, s[8:11], s70 offen offset:0 lds
    s_waitcnt lgkmcnt(10)
    v_mfma_f32_32x32x16_bf16 v[48:63], a[4:7], v[176:179], v[48:63]
    ds_read_b64_tr_b16 a[20:21], v17 offset:38912
    ds_read_b64_tr_b16 a[22:23], v17 offset:39424
    ds_read_b128 a[40:43], v23 offset:39360
    buffer_load_dwordx4 v2, s[8:11], s70 offen offset:1024 lds
    s_waitcnt lgkmcnt(12)
    v_mfma_f32_16x16x32_bf16 v[96:99], v[176:179], a[32:35], v[96:99]
    s_waitcnt lgkmcnt(9)
    v_mfma_f32_32x32x16_bf16 v[32:47], a[8:11], v[180:183], v[32:47]
    ds_read_b128 v[188:191], v8 offset:12288
    ds_read_b64_tr_b16 a[24:25], v15 offset:14336
    ds_read_b64_tr_b16 a[26:27], v15 offset:14848
    buffer_load_dwordx4 v3, s[8:11], s70 offen offset:2048 lds
    s_waitcnt lgkmcnt(10)
    v_mfma_f32_32x32x16_bf16 v[48:63], a[12:15], v[180:183], v[48:63]
    ds_read_b64_tr_b16 a[28:29], v18 offset:14336
    ds_read_b64_tr_b16 a[30:31], v18 offset:14848
    ds_read_b128 a[44:47], v23 offset:39392
    buffer_load_dwordx4 v4, s[8:11], s70 offen offset:3072 lds
    s_waitcnt lgkmcnt(12)
    v_mfma_f32_16x16x32_bf16 v[96:99], v[180:183], a[36:39], v[96:99]
    s_waitcnt lgkmcnt(9)
    v_mfma_f32_32x32x16_bf16 v[32:47], a[16:19], v[184:187], v[32:47]
    s_waitcnt vmcnt(12)
    s_barrier
    ds_read_b128 v[192:195], v5 offset:0
    ds_read_b64_tr_b16 a[0:1], v13 offset:24576
    ds_read_b64_tr_b16 a[2:3], v13 offset:25088
    s_waitcnt lgkmcnt(10)
    v_mfma_f32_32x32x16_bf16 v[48:63], a[20:23], v[184:187], v[48:63]
    ds_read_b64_tr_b16 a[4:5], v16 offset:24576
    ds_read_b64_tr_b16 a[6:7], v16 offset:25088
    ds_read_b128 a[32:35], v23 offset:39424
    s_add_u32 m0, s7, 30720
    s_nop 0
    buffer_load_dwordx4 v9, s[12:15], s79 offen offset:0 lds
    s_waitcnt lgkmcnt(12)
    v_mfma_f32_16x16x32_bf16 v[96:99], v[184:187], a[40:43], v[96:99]
    s_waitcnt lgkmcnt(9)
    v_mfma_f32_32x32x16_bf16 v[32:47], a[24:27], v[188:191], v[32:47]
    ds_read_b128 v[196:199], v6 offset:0
    ds_read_b64_tr_b16 a[8:9], v14 offset:0
    ds_read_b64_tr_b16 a[10:11], v14 offset:512
    buffer_load_dwordx4 v10, s[12:15], s79 offen offset:1024 lds
    s_waitcnt lgkmcnt(10)
    v_mfma_f32_32x32x16_bf16 v[48:63], a[28:31], v[188:191], v[48:63]
    ds_read_b64_tr_b16 a[12:13], v17 offset:0
    ds_read_b64_tr_b16 a[14:15], v17 offset:512
    ds_read_b128 a[36:39], v23 offset:39456
    s_add_u32 m0, s7, 12288
    s_nop 0
    buffer_load_dwordx4 v1, s[8:11], s71 offen offset:0 lds
    s_waitcnt lgkmcnt(12)
    v_mfma_f32_16x16x32_bf16 v[96:99], v[188:191], a[44:47], v[96:99]
    v_dot2c_f32_bf16 v26, v176, v176
    v_dot2c_f32_bf16 v26, v177, v177
    v_dot2c_f32_bf16 v26, v178, v178
    v_dot2c_f32_bf16 v26, v179, v179
    v_dot2c_f32_bf16 v26, v180, v180
    v_dot2c_f32_bf16 v26, v181, v181
    v_dot2c_f32_bf16 v26, v182, v182
    v_dot2c_f32_bf16 v26, v183, v183
    v_dot2c_f32_bf16 v26, v184, v184
    v_dot2c_f32_bf16 v26, v185, v185
    v_dot2c_f32_bf16 v26, v186, v186
    v_dot2c_f32_bf16 v26, v187, v187
    v_dot2c_f32_bf16 v26, v188, v188
    v_dot2c_f32_bf16 v26, v189, v189
    v_dot2c_f32_bf16 v26, v190, v190
    v_dot2c_f32_bf16 v26, v191, v191
    s_waitcnt lgkmcnt(9)
    v_mfma_f32_32x32x16_bf16 v[32:47], a[0:3], v[192:195], v[32:47]
    ds_read_b128 v[200:203], v7 offset:0
    ds_read_b64_tr_b16 a[16:17], v14 offset:40960
    ds_read_b64_tr_b16 a[18:19], v14 offset:41472
    buffer_load_dwordx4 v2, s[8:11], s71 offen offset:1024 lds
    s_waitcnt lgkmcnt(10)
    v_mfma_f32_32x32x16_bf16 v[48:63], a[4:7], v[192:195], v[48:63]
    ds_read_b64_tr_b16 a[20:21], v17 offset:40960
    ds_read_b64_tr_b16 a[22:23], v17 offset:41472
    ds_read_b128 a[40:43], v23 offset:39488
    buffer_load_dwordx4 v3, s[8:11], s71 offen offset:2048 lds
    s_waitcnt lgkmcnt(12)
    v_mfma_f32_16x16x32_bf16 v[96:99], v[192:195], a[32:35], v[96:99]
    s_waitcnt lgkmcnt(9)
    v_mfma_f32_32x32x16_bf16 v[32:47], a[8:11], v[196:199], v[32:47]
    ds_read_b128 v[204:207], v8 offset:0
    ds_read_b64_tr_b16 a[24:25], v15 offset:16384
    ds_read_b64_tr_b16 a[26:27], v15 offset:16896
    buffer_load_dwordx4 v4, s[8:11], s71 offen offset:3072 lds
    s_waitcnt lgkmcnt(10)
    v_mfma_f32_32x32x16_bf16 v[48:63], a[12:15], v[196:199], v[48:63]
    ds_read_b64_tr_b16 a[28:29], v18 offset:16384
    ds_read_b64_tr_b16 a[30:31], v18 offset:16896
    ds_read_b128 a[44:47], v23 offset:39520
    s_add_u32 m0, s7, 32768
    s_nop 0
    buffer_load_dwordx4 v80, s[16:19], s80 offen offset:0 lds
    s_waitcnt lgkmcnt(12)
    v_mfma_f32_16x16x32_bf16 v[96:99], v[196:199], a[36:39], v[96:99]
    s_waitcnt lgkmcnt(9)
    v_mfma_f32_32x32x16_bf16 v[32:47], a[16:19], v[200:203], v[32:47]
    s_waitcnt vmcnt(13)
    s_barrier
    ds_read_b128 v[208:211], v5 offset:4096
    ds_read_b64_tr_b16 a[0:1], v13 offset:26624
    ds_read_b64_tr_b16 a[2:3], v13 offset:27136
    s_waitcnt lgkmcnt(10)
    v_mfma_f32_32x32x16_bf16 v[48:63], a[20:23], v[200:203], v[48:63]
    ds_read_b64_tr_b16 a[4:5], v16 offset:26624
    ds_read_b64_tr_b16 a[6:7], v16 offset:27136
    ds_read_b128 a[32:35], v23 offset:39552
    buffer_load_dwordx4 v81, s[16:19], s80 offen offset:1024 lds
    s_waitcnt lgkmcnt(12)
    v_mfma_f32_16x16x32_bf16 v[96:99], v[200:203], a[40:43], v[96:99]
    s_waitcnt lgkmcnt(9)
    v_mfma_f32_32x32x16_bf16 v[32:47], a[24:27], v[204:207], v[32:47]
    ds_read_b128 v[212:215], v6 offset:4096
    ds_read_b64_tr_b16 a[8:9], v14 offset:2048
    ds_read_b64_tr_b16 a[10:11], v14 offset:2560
    buffer_load_dwordx4 v82, s[16:19], s80 offen offset:2048 lds
    s_waitcnt lgkmcnt(10)
    v_mfma_f32_32x32x16_bf16 v[48:63], a[28:31], v[204:207], v[48:63]
    ds_read_b64_tr_b16 a[12:13], v17 offset:2048
    ds_read_b64_tr_b16 a[14:15], v17 offset:2560
    ds_read_b128 a[36:39], v23 offset:39584
    s_add_u32 m0, s7, 35840
    s_nop 0
    buffer_load_dwordx4 v80, s[16:19], s81 offen offset:0 lds
    s_waitcnt lgkmcnt(12)
    v_mfma_f32_16x16x32_bf16 v[96:99], v[204:207], a[44:47], v[96:99]
    v_dot2c_f32_bf16 v26, v192, v192
    v_dot2c_f32_bf16 v26, v193, v193
    v_dot2c_f32_bf16 v26, v194, v194
    v_dot2c_f32_bf16 v26, v195, v195
    v_dot2c_f32_bf16 v26, v196, v196
    v_dot2c_f32_bf16 v26, v197, v197
    v_dot2c_f32_bf16 v26, v198, v198
    v_dot2c_f32_bf16 v26, v199, v199
    v_dot2c_f32_bf16 v26, v200, v200
    v_dot2c_f32_bf16 v26, v201, v201
    v_dot2c_f32_bf16 v26, v202, v202
    v_dot2c_f32_bf16 v26, v203, v203
    v_dot2c_f32_bf16 v26, v204, v204
    v_dot2c_f32_bf16 v26, v205, v205
    v_dot2c_f32_bf16 v26, v206, v206
    v_dot2c_f32_bf16 v26, v207, v207
    s_waitcnt lgkmcnt(9)
    v_mfma_f32_32x32x16_bf16 v[32:47], a[0:3], v[208:211], v[32:47]
    ds_read_b128 v[216:219], v7 offset:4096
    ds_read_b64_tr_b16 a[16:17], v14 offset:43008
    ds_read_b64_tr_b16 a[18:19], v14 offset:43520
    buffer_load_dwordx4 v81, s[16:19], s81 offen offset:1024 lds
    s_waitcnt lgkmcnt(10)
    v_mfma_f32_32x32x16_bf16 v[48:63], a[4:7], v[208:211], v[48:63]
    ds_read_b64_tr_b16 a[20:21], v17 offset:43008
    ds_read_b64_tr_b16 a[22:23], v17 offset:43520
    ds_read_b128 a[40:43], v23 offset:39616
    buffer_load_dwordx4 v82, s[16:19], s81 offen offset:2048 lds
    s_waitcnt lgkmcnt(12)
    v_mfma_f32_16x16x32_bf16 v[96:99], v[208:211], a[32:35], v[96:99]
    s_waitcnt lgkmcnt(9)
    v_mfma_f32_32x32x16_bf16 v[32:47], a[8:11], v[212:215], v[32:47]
    ds_read_b128 v[220:223], v8 offset:4096
    ds_read_b64_tr_b16 a[24:25], v15 offset:18432
    ds_read_b64_tr_b16 a[26:27], v15 offset:18944
    buffer_load_dword a249, v12, s[12:15], s72 offen
    s_waitcnt lgkmcnt(10)
    v_mfma_f32_32x32x16_bf16 v[48:63], a[12:15], v[212:215], v[48:63]
    ds_read_b64_tr_b16 a[28:29], v18 offset:18432
    ds_read_b64_tr_b16 a[30:31], v18 offset:18944
    ds_read_b128 a[44:47], v23 offset:39648
    s_add_u32 m0, s7, 40448
    s_nop 0
    buffer_load_dword v88, s[88:91], s63 offen lds
    s_waitcnt lgkmcnt(12)
    v_mfma_f32_16x16x32_bf16 v[96:99], v[212:215], a[36:39], v[96:99]
    s_waitcnt lgkmcnt(9)
    v_mfma_f32_32x32x16_bf16 v[32:47], a[16:19], v[216:219], v[32:47]
    s_waitcnt vmcnt(14)
    s_barrier
    ds_read_b128 v[224:227], v5 offset:8192
    ds_read_b64_tr_b16 a[0:1], v13 offset:28672
    ds_read_b64_tr_b16 a[2:3], v13 offset:29184
    s_waitcnt lgkmcnt(10)
    v_mfma_f32_32x32x16_bf16 v[48:63], a[20:23], v[216:219], v[48:63]
    ds_read_b64_tr_b16 a[4:5], v16 offset:28672
    ds_read_b64_tr_b16 a[6:7], v16 offset:29184
    ds_read_b128 a[32:35], v23 offset:39680
    buffer_load_dwordx2 v[86:87], off, s[48:51], 0 sc1
    s_waitcnt lgkmcnt(12)
    v_mfma_f32_16x16x32_bf16 v[96:99], v[216:219], a[40:43], v[96:99]
    s_waitcnt lgkmcnt(9)
    v_mfma_f32_32x32x16_bf16 v[32:47], a[24:27], v[220:223], v[32:47]
    ds_read_b128 v[228:231], v6 offset:8192
    ds_read_b64_tr_b16 a[8:9], v14 offset:4096
    ds_read_b64_tr_b16 a[10:11], v14 offset:4608
    s_waitcnt lgkmcnt(10)
    v_mfma_f32_32x32x16_bf16 v[48:63], a[28:31], v[220:223], v[48:63]
    ds_read_b64_tr_b16 a[12:13], v17 offset:4096
    ds_read_b64_tr_b16 a[14:15], v17 offset:4608
    ds_read_b128 a[36:39], v23 offset:39712
    s_waitcnt lgkmcnt(12)
    v_mfma_f32_16x16x32_bf16 v[96:99], v[220:223], a[44:47], v[96:99]
    v_dot2c_f32_bf16 v26, v208, v208
    v_dot2c_f32_bf16 v26, v209, v209
    v_dot2c_f32_bf16 v26, v210, v210
    v_dot2c_f32_bf16 v26, v211, v211
    v_dot2c_f32_bf16 v26, v212, v212
    v_dot2c_f32_bf16 v26, v213, v213
    v_dot2c_f32_bf16 v26, v214, v214
    v_dot2c_f32_bf16 v26, v215, v215
    v_dot2c_f32_bf16 v26, v216, v216
    v_dot2c_f32_bf16 v26, v217, v217
    v_dot2c_f32_bf16 v26, v218, v218
    v_dot2c_f32_bf16 v26, v219, v219
    v_dot2c_f32_bf16 v26, v220, v220
    v_dot2c_f32_bf16 v26, v221, v221
    v_dot2c_f32_bf16 v26, v222, v222
    v_dot2c_f32_bf16 v26, v223, v223
    s_waitcnt lgkmcnt(9)
    v_mfma_f32_32x32x16_bf16 v[32:47], a[0:3], v[224:227], v[32:47]
    ds_read_b128 v[232:235], v7 offset:8192
    ds_read_b64_tr_b16 a[16:17], v14 offset:45056
    ds_read_b64_tr_b16 a[18:19], v14 offset:45568
    s_waitcnt lgkmcnt(10)
    v_mfma_f32_32x32x16_bf16 v[48:63], a[4:7], v[224:227], v[48:63]
    ds_read_b64_tr_b16 a[20:21], v17 offset:45056
    ds_read_b64_tr_b16 a[22:23], v17 offset:45568
    ds_read_b128 a[40:43], v23 offset:39744
    s_waitcnt lgkmcnt(12)
    v_mfma_f32_16x16x32_bf16 v[96:99], v[224:227], a[32:35], v[96:99]
    s_waitcnt lgkmcnt(9)
    v_mfma_f32_32x32x16_bf16 v[32:47], a[8:11], v[228:231], v[32:47]
    ds_read_b128 v[236:239], v8 offset:8192
    ds_read_b64_tr_b16 a[24:25], v15 offset:20480
    ds_read_b64_tr_b16 a[26:27], v15 offset:20992
    s_waitcnt lgkmcnt(10)
    v_mfma_f32_32x32x16_bf16 v[48:63], a[12:15], v[228:231], v[48:63]
    ds_read_b64_tr_b16 a[28:29], v18 offset:20480
    ds_read_b64_tr_b16 a[30:31], v18 offset:20992
    ds_read_b128 a[44:47], v23 offset:39776
    s_waitcnt lgkmcnt(12)
    v_mfma_f32_16x16x32_bf16 v[96:99], v[228:231], a[36:39], v[96:99]
    s_waitcnt lgkmcnt(9)
    v_mfma_f32_32x32x16_bf16 v[32:47], a[16:19], v[232:235], v[32:47]
    s_waitcnt vmcnt(9)
    s_barrier
    ds_read_b128 v[240:243], v5 offset:12288
    ds_read_b64_tr_b16 a[0:1], v13 offset:30720
    ds_read_b64_tr_b16 a[2:3], v13 offset:31232
    s_waitcnt lgkmcnt(10)
    v_mfma_f32_32x32x16_bf16 v[48:63], a[20:23], v[232:235], v[48:63]
    ds_read_b64_tr_b16 a[4:5], v16 offset:30720
    ds_read_b64_tr_b16 a[6:7], v16 offset:31232
    ds_read_b128 a[32:35], v23 offset:39808
    s_waitcnt lgkmcnt(12)
    v_mfma_f32_16x16x32_bf16 v[96:99], v[232:235], a[40:43], v[96:99]
    s_waitcnt lgkmcnt(9)
    v_mfma_f32_32x32x16_bf16 v[32:47], a[24:27], v[236:239], v[32:47]
    ds_read_b128 v[244:247], v6 offset:12288
    ds_read_b64_tr_b16 a[8:9], v14 offset:6144
    ds_read_b64_tr_b16 a[10:11], v14 offset:6656
    s_add_u32 m0, s7, 0
    s_nop 0
    buffer_load_dwordx4 v80, s[16:19], s82 offen offset:0 lds
    s_waitcnt lgkmcnt(10)
    v_mfma_f32_32x32x16_bf16 v[48:63], a[28:31], v[236:239], v[48:63]
    ds_read_b64_tr_b16 a[12:13], v17 offset:6144
    ds_read_b64_tr_b16 a[14:15], v17 offset:6656
    ds_read_b128 a[36:39], v23 offset:39840
    buffer_load_dwordx4 v81, s[16:19], s82 offen offset:1024 lds
    s_waitcnt lgkmcnt(12)
    v_mfma_f32_16x16x32_bf16 v[96:99], v[236:239], a[44:47], v[96:99]
    v_dot2c_f32_bf16 v26, v224, v224
    v_dot2c_f32_bf16 v26, v225, v225
    v_dot2c_f32_bf16 v26, v226, v226
    v_dot2c_f32_bf16 v26, v227, v227
    v_dot2c_f32_bf16 v26, v228, v228
    v_dot2c_f32_bf16 v26, v229, v229
    v_dot2c_f32_bf16 v26, v230, v230
    v_dot2c_f32_bf16 v26, v231, v231
    v_dot2c_f32_bf16 v26, v232, v232
    v_dot2c_f32_bf16 v26, v233, v233
    v_dot2c_f32_bf16 v26, v234, v234
    v_dot2c_f32_bf16 v26, v235, v235
    v_dot2c_f32_bf16 v26, v236, v236
    v_dot2c_f32_bf16 v26, v237, v237
    v_dot2c_f32_bf16 v26, v238, v238
    v_dot2c_f32_bf16 v26, v239, v239
    s_waitcnt lgkmcnt(9)
    v_mfma_f32_32x32x16_bf16 v[32:47], a[0:3], v[240:243], v[32:47]
    ds_read_b128 v[248:251], v7 offset:12288
    ds_read_b64_tr_b16 a[16:17], v14 offset:47104
    ds_read_b64_tr_b16 a[18:19], v14 offset:47616
    buffer_load_dwordx4 v82, s[16:19], s82 offen offset:2048 lds
    s_waitcnt lgkmcnt(10)
    v_mfma_f32_32x32x16_bf16 v[48:63], a[4:7], v[240:243], v[48:63]
    ds_read_b64_tr_b16 a[20:21], v17 offset:47104
    ds_read_b64_tr_b16 a[22:23], v17 offset:47616
    ds_read_b128 a[40:43], v23 offset:39872
    s_waitcnt lgkmcnt(12)
    v_mfma_f32_16x16x32_bf16 v[96:99], v[240:243], a[32:35], v[96:99]
    s_waitcnt lgkmcnt(9)
    v_mfma_f32_32x32x16_bf16 v[32:47], a[8:11], v[244:247], v[32:47]
    ds_read_b128 v[252:255], v8 offset:12288
    ds_read_b64_tr_b16 a[24:25], v15 offset:22528
    ds_read_b64_tr_b16 a[26:27], v15 offset:23040
    s_waitcnt lgkmcnt(10)
    v_mfma_f32_32x32x16_bf16 v[48:63], a[12:15], v[244:247], v[48:63]
    ds_read_b64_tr_b16 a[28:29], v18 offset:22528
    ds_read_b64_tr_b16 a[30:31], v18 offset:23040
    ds_read_b128 a[44:47], v23 offset:39904
    s_waitcnt lgkmcnt(12)
    v_mfma_f32_16x16x32_bf16 v[96:99], v[244:247], a[36:39], v[96:99]
    s_waitcnt lgkmcnt(9)
    v_mfma_f32_32x32x16_bf16 v[32:47], a[16:19], v[248:251], v[32:47]
    s_waitcnt lgkmcnt(7)
    v_mfma_f32_32x32x16_bf16 v[48:63], a[20:23], v[248:251], v[48:63]
    s_waitcnt lgkmcnt(6)
    v_mfma_f32_16x16x32_bf16 v[96:99], v[248:251], a[40:43], v[96:99]
    s_waitcnt lgkmcnt(3)
    v_mfma_f32_32x32x16_bf16 v[32:47], a[24:27], v[252:255], v[32:47]
    s_waitcnt lgkmcnt(1)
    v_mfma_f32_32x32x16_bf16 v[48:63], a[28:31], v[252:255], v[48:63]
    s_waitcnt lgkmcnt(0)
    v_mfma_f32_16x16x32_bf16 v[96:99], v[252:255], a[44:47], v[96:99]
L_kv_done:
    v_dot2c_f32_bf16 v26, v240, v240
    s_add_u32 m0, s7, 3072
    s_nop 0
    buffer_load_dwordx4 v80, s[16:19], s83 offen offset:0 lds
    v_dot2c_f32_bf16 v26, v241, v241
    v_dot2c_f32_bf16 v26, v242, v242
    v_dot2c_f32_bf16 v26, v243, v243
    v_dot2c_f32_bf16 v26, v244, v244
    v_dot2c_f32_bf16 v26, v245, v245
    v_dot2c_f32_bf16 v26, v246, v246
    v_dot2c_f32_bf16 v26, v247, v247
    buffer_load_dwordx4 v81, s[16:19], s83 offen offset:1024 lds
    v_dot2c_f32_bf16 v26, v248, v248
    v_dot2c_f32_bf16 v26, v249, v249
    v_dot2c_f32_bf16 v26, v250, v250
    v_dot2c_f32_bf16 v26, v251, v251
    v_dot2c_f32_bf16 v26, v252, v252
    v_dot2c_f32_bf16 v26, v253, v253
    v_dot2c_f32_bf16 v26, v254, v254
    v_dot2c_f32_bf16 v26, v255, v255
    v_and_b32 v100, 3, v0
    v_lshlrev_b32 v100, 6, v100
    v_and_b32 v101, 48, v0
    v_add3_u32 v100, v100, v101, s7
    v_and_b32_e64 v101, 31, v0
    v_lshl_add_u32 v101, v101, 2, s7
    s_mov_b32 exec_lo, 0x000f000f
    s_mov_b32 exec_hi, 0x000f000f
    ds_write_b128 v100, v[96:99] offset:40704
    s_mov_b64 exec, -1
    ds_read_b32 v25, v101 offset:40704
    ds_read_b32 v11, v101 offset:40832
    v_cvt_pk_bf16_f32 v64, v32, v33
    buffer_load_dwordx4 v82, s[16:19], s83 offen offset:2048 lds
    v_cvt_pk_bf16_f32 v65, v34, v35
    v_cvt_pk_bf16_f32 v66, v36, v37
    v_cvt_pk_bf16_f32 v67, v38, v39
    v_cvt_pk_bf16_f32 v68, v40, v41
    v_cvt_pk_bf16_f32 v69, v42, v43
    v_cvt_pk_bf16_f32 v70, v44, v45
    v_cvt_pk_bf16_f32 v71, v46, v47
    v_cvt_pk_bf16_f32 v72, v48, v49
    v_cvt_pk_bf16_f32 v73, v50, v51
    v_cvt_pk_bf16_f32 v74, v52, v53
    v_cvt_pk_bf16_f32 v75, v54, v55
    v_cvt_pk_bf16_f32 v76, v56, v57
    v_cvt_pk_bf16_f32 v77, v58, v59
    s_add_u32 m0, s7, 6144
    s_nop 0
    buffer_load_dwordx4 v80, s[16:19], s84 offen offset:0 lds
    v_cvt_pk_bf16_f32 v78, v60, v61
    v_cvt_pk_bf16_f32 v79, v62, v63
    v_mov_b32_e64 v120, v26
    buffer_store_dwordx4 v[64:67], v24, s[28:31], s59 offen offset:0 sc1
    s_nop 0
    v_permlane32_swap_b32 v120, v26
    v_add_f32 v26, v26, v120
    s_waitcnt lgkmcnt(1)
    v_mul_f32 v25, 0x3b000000, v25
    v_mul_f32 v26, 0x3b000000, v26
    v_fma_f32 v26, -v25, v25, v26
    v_max_f32_e64 v26, 0, v26
    buffer_store_dwordx4 v[68:71], v24, s[28:31], s59 offen offset:1024 sc1
    v_cvt_pk_bf16_f32 v28, -v25, -v25
    v_cvt_pk_bf16_f32 v26, v26, v26
    v_lshlrev_b32_e64 v26, 16, v26
    v_add_f32 v26, 0x3727c5ac, v26
    v_cvt_pk_bf16_f32 v26, v26, v26
    v_lshlrev_b32_e64 v26, 16, v26
    s_add_u32 s55, s59, 262144
    buffer_store_dwordx4 v[72:75], v24, s[28:31], s55 offen offset:0 sc1
    v_sqrt_f32 v26, v26
    s_waitcnt lgkmcnt(0)
    v_cvt_pk_bf16_f32 v11, v11, v11
    v_lshlrev_b32_e64 v11, 16, v11
    v_cvt_pk_bf16_f32 v29, v26, 0
    v_mul_f32 v11, 0xbfb8aa3b, v11
    v_lshlrev_b32_e64 v18, 16, v29
    buffer_store_dwordx4 v[76:79], v24, s[28:31], s55 offen offset:1024 sc1
    v_exp_f32 v11, v11
    v_rcp_f32 v120, v18
    v_cmp_gt_u32 vcc, 32, v0
    v_add_f32 v11, 1.0, v11
    v_mul_f32 v121, v120, v120
    v_rcp_f32 v11, v11
    v_mul_f32 v14, 0xc0135761, v120
    v_cndmask_b32 v28, 0, v28, vcc
    v_cndmask_b32 v29, 0, v29, vcc
    v_mul_f32_e64 v121, v121, v14
    v_mul_f32 v16, 0x3d372713, v121
    v_cvt_pk_bf16_f32 v11, v11, v11
    v_lshlrev_b32 v11, 16, v11
    s_lshl_b32 s54, s3, 7
    s_add_u32 s54, s54, 39936
    v_and_b32 v120, 31, v0
    v_lshlrev_b32 v121, 2, v120
    v_add_u32 v121, 162816, v121
    v_lshl_add_u32 v121, s3, 7, v121
    v_lshlrev_b32_e64 v10, 2, v120
    v_add_u32 v10, 39936, v10
    v_lshl_add_u32 v15, v120, 1, s7
    v_and_b32 v120, 1, v0
    v_lshlrev_b32 v120, 6, v120
    v_and_b32_e64 v5, 48, v0
    v_add3_u32 v5, v5, v120, s54
    ds_write_b32 v121, v11
    v_lshrrev_b32 v122, 5, v0
    v_lshlrev_b32 v122, 9, v122
    v_sub_u32 v3, v13, v122
    v_add_u32 v3, s7, v3
    v_mov_b32 v122, s3
    v_and_b32 v123, 2, v122
    v_lshlrev_b32_e64 v123, 5, v123
    buffer_load_dwordx4 v81, s[16:19], s84 offen offset:1024 lds
    v_xor_b32 v3, v3, v123
    v_xor_b32 v4, 64, v3
    v_and_b32_e64 v122, 1, v122
    v_lshl_add_u32 v25, v122, 10, v24
    v_xor_b32 v26, 0x400, v25
    v_lshrrev_b32 v122, 3, v0
    v_and_b32 v123, 7, v0
    v_bfe_u32 v1, v0, 4, 1
    v_lshlrev_b32 v1, 2, v1
    v_xor_b32 v123, v123, v1
    v_lshlrev_b32_e64 v123, 4, v123
    v_lshl_add_u32 v1, v122, 10, v123
    v_add_u32 v2, 7168, v1
    v_lshrrev_b32 v122, 2, v0
    v_lshlrev_b32 v122, 5, v122
    v_and_b32_e64 v123, 1, v0
    v_lshl_add_u32 v122, v123, 3, v122
    s_and_b32 s54, s5, 1
    s_lshl_b32 s98, s54, 11
    s_lshl_b32 s54, s54, 4
    s_lshl_b32 s55, s4, 9
    s_add_u32 s54, s54, s55
    s_add_u32 s54, s54, 12288
    v_add_u32 v13, s54, v122
    s_mul_i32 s8, s3, 45056
    s_lshr_b32 s9, s3, 1
    s_lshl_b32 s9, s9, 16
    s_add_u32 s9, s9, s98
    s_mov_b32 s10, 8192
    v_bfe_u32 v122, v0, 1, 2
    buffer_load_dwordx4 v82, s[16:19], s84 offen offset:2048 lds
    v_min_u32 v122, 2, v122
    v_lshl_add_u32 v122, v122, 2, s97
    v_max_i32 v122, 0, v122
    v_lshrrev_b32 v123, 2, v122
    v_lshlrev_b32 v123, 9, v123
    v_and_b32 v122, 3, v122
    v_lshl_add_u32 v123, v122, 3, v123
    s_add_u32 m0, s7, 9216
    s_nop 0
    buffer_load_dwordx4 v80, s[16:19], s85 offen offset:0 lds
    v_and_b32 v122, 1, v0
    v_lshl_add_u32 v123, v122, 8, v123
    s_lshr_b32 s55, s5, 1
    s_lshl_b32 s55, s55, 5
    s_add_u32 s55, s55, 4096
    v_add_u32 v23, s55, v123
    v_and_b32 v120, 32, v0
    v_lshlrev_b32_e64 v120, 4, v120
    s_add_u32 s54, s97, 0
    s_cmp_lt_i32 s54, 0
    s_cselect_b64 vcc, -1, 0
    s_cselect_b32 s64, 0, s54
    s_cselect_b32 s65, 64, s54
    v_cndmask_b32 v121, v24, v120, vcc
    s_lshl_b32 s64, s64, 12
    s_lshl_b32 s65, s65, 12
    s_add_u32 s54, s97, 4
    s_cmp_lt_i32 s54, 0
    s_cselect_b64 vcc, -1, 0
    s_cselect_b32 s66, 0, s54
    s_cselect_b32 s67, 64, s54
    v_cndmask_b32 v122, v24, v120, vcc
    s_lshl_b32 s66, s66, 12
    s_lshl_b32 s67, s67, 12
    s_add_u32 s54, s97, 8
    s_cmp_lt_i32 s54, 0
    s_cselect_b64 vcc, -1, 0
    s_cselect_b32 s68, 0, s54
    s_cselect_b32 s69, 64, s54
    v_cndmask_b32 v123, v24, v120, vcc
    s_lshl_b32 s68, s68, 12
    s_lshl_b32 s69, s69, 12
    v_add_u32 v17, 81920, v5
    buffer_load_dwordx4 v81, s[16:19], s85 offen offset:1024 lds
    v_add_u32 v89, 40960, v10
    v_add_u32 v90, 81920, v10
    s_waitcnt vmcnt(21)
    s_barrier
    ds_read_b64_tr_b16 a[36:37], v22 offset:32768
    ds_read_b64_tr_b16 a[38:39], v22 offset:33536
    ds_read_b64_tr_b16 a[40:41], v22 offset:32832
    ds_read_b64_tr_b16 a[42:43], v22 offset:33600
    ds_read_b64_tr_b16 a[44:45], v22 offset:32896
    ds_read_b64_tr_b16 a[46:47], v22 offset:33664
    ds_read_b64_tr_b16 a[0:1], v83 offset:32768
    ds_read_b64_tr_b16 a[2:3], v83 offset:33536
    ds_read_b64_tr_b16 a[4:5], v83 offset:32832
    ds_read_b64_tr_b16 a[6:7], v83 offset:33600
    ds_read_b64_tr_b16 a[8:9], v83 offset:32896
    ds_read_b64_tr_b16 a[10:11], v83 offset:33664
    ds_read_b64_tr_b16 a[12:13], v84 offset:8192
    ds_read_b64_tr_b16 a[14:15], v84 offset:8960
    ds_read_b64_tr_b16 a[16:17], v84 offset:8256
    ds_read_b64_tr_b16 a[18:19], v84 offset:9024
    ds_read_b64_tr_b16 a[20:21], v84 offset:8320
    ds_read_b64_tr_b16 a[22:23], v84 offset:9088
    s_waitcnt lgkmcnt(10)
    v_mfma_f32_32x32x16_bf16 v[32:47], a[0:3], v[128:131], 0
    ds_read_b64_tr_b16 a[24:25], v84 offset:49152
    ds_read_b64_tr_b16 a[26:27], v84 offset:49920
    buffer_load_dwordx4 v82, s[16:19], s85 offen offset:2048 lds
    s_waitcnt lgkmcnt(10)
    v_mfma_f32_32x32x16_bf16 v[48:63], a[4:7], v[128:131], 0
    ds_read_b64_tr_b16 a[28:29], v84 offset:49216
    ds_read_b64_tr_b16 a[30:31], v84 offset:49984
    s_waitcnt lgkmcnt(10)
    v_mfma_f32_32x32x16_bf16 v[64:79], a[8:11], v[128:131], 0
    ds_read_b64_tr_b16 a[32:33], v84 offset:49280
    ds_read_b64_tr_b16 a[34:35], v84 offset:50048
    s_add_u32 m0, s7, 12288
    s_nop 0
    buffer_load_dwordx4 v80, s[16:19], s86 offen offset:0 lds
    s_waitcnt lgkmcnt(10)
    v_mfma_f32_32x32x16_bf16 v[32:47], a[12:15], v[132:135], v[32:47]
    ds_read_b64_tr_b16 a[0:1], v85 offset:24576
    ds_read_b64_tr_b16 a[2:3], v85 offset:25344
    v_mfma_f32_16x16x32_bf16 v[96:99], a[36:39], v[92:95], 0
    s_waitcnt lgkmcnt(10)
    v_mfma_f32_32x32x16_bf16 v[48:63], a[16:19], v[132:135], v[48:63]
    ds_read_b64_tr_b16 a[4:5], v85 offset:24640
    ds_read_b64_tr_b16 a[6:7], v85 offset:25408
    buffer_load_dwordx4 v81, s[16:19], s86 offen offset:1024 lds
    v_mfma_f32_16x16x32_bf16 v[100:103], a[40:43], v[92:95], 0
    s_waitcnt lgkmcnt(10)
    v_mfma_f32_32x32x16_bf16 v[64:79], a[20:23], v[132:135], v[64:79]
    ds_read_b64_tr_b16 a[8:9], v85 offset:24704
    ds_read_b64_tr_b16 a[10:11], v85 offset:25472
    s_waitcnt vmcnt(18)
    v_readfirstlane_b32 s52, v86
    s_nop 0
    s_cmp_eq_u32 s52, 0
    s_cbranch_scc1 Lnon_1
Lnonb_2:
    v_readfirstlane_b32 s53, v87
    v_mfma_f32_16x16x32_bf16 v[104:107], a[44:47], v[92:95], 0
    v_mov_b32 v6, v86
    v_mov_b32 v7, v87
    s_waitcnt lgkmcnt(10)
    v_mfma_f32_32x32x16_bf16 v[32:47], a[24:27], v[136:139], v[32:47]
    s_barrier
    ds_read_b64_tr_b16 a[12:13], v83 offset:35840
    ds_read_b64_tr_b16 a[14:15], v83 offset:36608
    buffer_load_dwordx4 v82, s[16:19], s86 offen offset:2048 lds
    s_waitcnt lgkmcnt(10)
    v_mfma_f32_32x32x16_bf16 v[48:63], a[28:31], v[136:139], v[48:63]
    ds_read_b64_tr_b16 a[16:17], v83 offset:35904
    ds_read_b64_tr_b16 a[18:19], v83 offset:36672
    s_waitcnt lgkmcnt(10)
    v_mfma_f32_32x32x16_bf16 v[64:79], a[32:35], v[136:139], v[64:79]
    ds_read_b64_tr_b16 a[20:21], v83 offset:35968
    ds_read_b64_tr_b16 a[22:23], v83 offset:36736
    s_add_u32 m0, s7, 24576
    s_nop 0
    buffer_load_dwordx4 v80, s[16:19], s87 offen offset:0 lds
    s_waitcnt lgkmcnt(10)
    v_mfma_f32_32x32x16_bf16 v[32:47], a[0:3], v[140:143], v[32:47]
    ds_read_b64_tr_b16 a[24:25], v84 offset:11264
    ds_read_b64_tr_b16 a[26:27], v84 offset:12032
    ds_read_b64_tr_b16 a[36:37], v22 offset:35840
    ds_read_b64_tr_b16 a[38:39], v22 offset:36608
    s_waitcnt lgkmcnt(12)
    v_mfma_f32_32x32x16_bf16 v[48:63], a[4:7], v[140:143], v[48:63]
    ds_read_b64_tr_b16 a[28:29], v84 offset:11328
    ds_read_b64_tr_b16 a[30:31], v84 offset:12096
    ds_read_b64_tr_b16 a[40:41], v22 offset:35904
    ds_read_b64_tr_b16 a[42:43], v22 offset:36672
    s_waitcnt lgkmcnt(14)
    v_mfma_f32_32x32x16_bf16 v[64:79], a[8:11], v[140:143], v[64:79]
    ds_read_b64_tr_b16 a[32:33], v84 offset:11392
    ds_read_b64_tr_b16 a[34:35], v84 offset:12160
    ds_read_b64_tr_b16 a[44:45], v22 offset:35968
    ds_read_b64_tr_b16 a[46:47], v22 offset:36736
    s_waitcnt lgkmcnt(15)
    v_mfma_f32_32x32x16_bf16 v[32:47], a[12:15], v[144:147], v[32:47]
    ds_read_b64_tr_b16 a[0:1], v84 offset:52224
    ds_read_b64_tr_b16 a[2:3], v84 offset:52992
    buffer_load_dwordx4 v81, s[16:19], s87 offen offset:1024 lds
    s_waitcnt lgkmcnt(15)
    v_mfma_f32_32x32x16_bf16 v[48:63], a[16:19], v[144:147], v[48:63]
    ds_read_b64_tr_b16 a[4:5], v84 offset:52288
    ds_read_b64_tr_b16 a[6:7], v84 offset:53056
    s_waitcnt lgkmcnt(15)
    v_mfma_f32_32x32x16_bf16 v[64:79], a[20:23], v[144:147], v[64:79]
    ds_read_b64_tr_b16 a[8:9], v84 offset:52352
    ds_read_b64_tr_b16 a[10:11], v84 offset:53120
    buffer_load_dwordx4 v82, s[16:19], s87 offen offset:2048 lds
    s_waitcnt vmcnt(11)
    s_waitcnt lgkmcnt(15)
    v_mfma_f32_32x32x16_bf16 v[32:47], a[24:27], v[148:151], v[32:47]
    ds_read_b64_tr_b16 a[12:13], v85 offset:27648
    ds_read_b64_tr_b16 a[14:15], v85 offset:28416
    s_mov_b64 exec, 1
    buffer_store_dwordx2 v[6:7], off, s[28:31], s58 sc0 sc1
    s_mov_b64 exec, -1
    s_waitcnt lgkmcnt(15)
    v_mfma_f32_16x16x32_bf16 v[96:99], a[36:39], v[92:95], v[96:99]
    v_lshrrev_b32_e64 v125, 4, v0
    v_min_u32 v125, 2, v125
    v_lshl_add_u32 v126, v125, 2, s97
    v_lshlrev_b32 v127, 29, v0
    v_or_b32 v126, v126, v127
    v_cmp_gt_i32 vcc, 0, v126
    s_waitcnt lgkmcnt(14)
    v_mfma_f32_32x32x16_bf16 v[48:63], a[28:31], v[148:151], v[48:63]
    ds_read_b64_tr_b16 a[16:17], v85 offset:27712
    ds_read_b64_tr_b16 a[18:19], v85 offset:28480
    s_lshr_b32 s96, s5, 1
    s_lshl_b32 s96, s96, 7
    s_add_u32 m0, s7, 40704
    s_nop 0
    buffer_load_dword v88, s[92:95], s96 offen lds
    s_waitcnt lgkmcnt(14)
    v_mfma_f32_16x16x32_bf16 v[100:103], a[40:43], v[92:95], v[100:103]
    v_mov_b32 v126, 0x3f803f80
    v_mul_u32_u24 v125, 4224, v125
    v_cndmask_b32 v126, v126, 0, vcc
    v_bfe_u32 v127, v0, 3, 1
    v_mul_u32_u24 v127, 1056, v127
    v_add_u32 v125, v125, v127
    s_waitcnt lgkmcnt(12)
    v_mfma_f32_32x32x16_bf16 v[64:79], a[32:35], v[148:151], v[64:79]
    ds_read_b64_tr_b16 a[20:21], v85 offset:27776
    ds_read_b64_tr_b16 a[22:23], v85 offset:28544
    v_min_u32 v11, 43, v0
    v_and_b32 v120, 3, v11
    v_lshrrev_b32 v11, 2, v11
    v_lshlrev_b32 v11, 10, v11
    v_lshl_add_u32 v11, v120, 7, v11
    buffer_load_dword a250, v11, s[20:23], s1 offen
    s_waitcnt lgkmcnt(12)
    v_mfma_f32_16x16x32_bf16 v[104:107], a[44:47], v[92:95], v[104:107]
    v_and_b32 v127, 7, v0
    v_lshl_add_u32 v125, v127, 2, v125
    v_add_u32 v125, s7, v125
    s_waitcnt lgkmcnt(10)
    v_mfma_f32_32x32x16_bf16 v[32:47], a[0:3], v[152:155], v[32:47]
    s_barrier
    ds_read_b64_tr_b16 a[24:25], v83 offset:0
    ds_read_b64_tr_b16 a[26:27], v83 offset:768
    v_and_b32 v11, 0xfff, v11
    buffer_load_dword a251, v11, s[24:27], s0 offen
    s_waitcnt lgkmcnt(10)
    v_mfma_f32_32x32x16_bf16 v[48:63], a[4:7], v[152:155], v[48:63]
    ds_read_b64_tr_b16 a[28:29], v83 offset:64
    ds_read_b64_tr_b16 a[30:31], v83 offset:832
    s_waitcnt lgkmcnt(10)
    v_mfma_f32_32x32x16_bf16 v[64:79], a[8:11], v[152:155], v[64:79]
    ds_read_b64_tr_b16 a[32:33], v83 offset:128
    ds_read_b64_tr_b16 a[34:35], v83 offset:896
    s_waitcnt lgkmcnt(10)
    v_mfma_f32_32x32x16_bf16 v[32:47], a[12:15], v[156:159], v[32:47]
    ds_read_b64_tr_b16 a[0:1], v83 offset:40960
    ds_read_b64_tr_b16 a[2:3], v83 offset:41728
    ds_read_b64_tr_b16 a[36:37], v22 offset:0
    ds_read_b64_tr_b16 a[38:39], v22 offset:768
    s_waitcnt lgkmcnt(12)
    v_mfma_f32_32x32x16_bf16 v[48:63], a[16:19], v[156:159], v[48:63]
    ds_read_b64_tr_b16 a[4:5], v83 offset:41024
    ds_read_b64_tr_b16 a[6:7], v83 offset:41792
    ds_read_b64_tr_b16 a[40:41], v22 offset:64
    ds_read_b64_tr_b16 a[42:43], v22 offset:832
    s_waitcnt lgkmcnt(14)
    v_mfma_f32_32x32x16_bf16 v[64:79], a[20:23], v[156:159], v[64:79]
    ds_read_b64_tr_b16 a[8:9], v83 offset:41088
    ds_read_b64_tr_b16 a[10:11], v83 offset:41856
    ds_read_b64_tr_b16 a[44:45], v22 offset:128
    ds_read_b64_tr_b16 a[46:47], v22 offset:896
    s_waitcnt lgkmcnt(15)
    v_mfma_f32_32x32x16_bf16 v[32:47], a[24:27], v[160:163], v[32:47]
    ds_read_b64_tr_b16 a[12:13], v84 offset:16384
    ds_read_b64_tr_b16 a[14:15], v84 offset:17152
    s_waitcnt lgkmcnt(15)
    v_mfma_f32_32x32x16_bf16 v[48:63], a[28:31], v[160:163], v[48:63]
    ds_read_b64_tr_b16 a[16:17], v84 offset:16448
    ds_read_b64_tr_b16 a[18:19], v84 offset:17216
    s_waitcnt lgkmcnt(15)
    v_mfma_f32_32x32x16_bf16 v[64:79], a[32:35], v[160:163], v[64:79]
    ds_read_b64_tr_b16 a[20:21], v84 offset:16512
    ds_read_b64_tr_b16 a[22:23], v84 offset:17280
    s_waitcnt lgkmcnt(15)
    v_mfma_f32_32x32x16_bf16 v[32:47], a[0:3], v[164:167], v[32:47]
    ds_read_b64_tr_b16 a[24:25], v84 offset:57344
    ds_read_b64_tr_b16 a[26:27], v84 offset:58112
    s_waitcnt lgkmcnt(15)
    v_mfma_f32_16x16x32_bf16 v[96:99], a[36:39], v[92:95], v[96:99]
    s_waitcnt lgkmcnt(14)
    v_mfma_f32_32x32x16_bf16 v[48:63], a[4:7], v[164:167], v[48:63]
    ds_read_b64_tr_b16 a[28:29], v84 offset:57408
    ds_read_b64_tr_b16 a[30:31], v84 offset:58176
    s_waitcnt lgkmcnt(14)
    v_mfma_f32_16x16x32_bf16 v[100:103], a[40:43], v[92:95], v[100:103]
    s_waitcnt lgkmcnt(12)
    v_mfma_f32_32x32x16_bf16 v[64:79], a[8:11], v[164:167], v[64:79]
    ds_read_b64_tr_b16 a[32:33], v84 offset:57472
    ds_read_b64_tr_b16 a[34:35], v84 offset:58240
    s_waitcnt lgkmcnt(12)
    v_mfma_f32_16x16x32_bf16 v[104:107], a[44:47], v[92:95], v[104:107]
    s_waitcnt lgkmcnt(10)
    v_mfma_f32_32x32x16_bf16 v[32:47], a[12:15], v[168:171], v[32:47]
    s_barrier
    ds_read_b64_tr_b16 a[0:1], v83 offset:3072
    ds_read_b64_tr_b16 a[2:3], v83 offset:3840
    s_waitcnt lgkmcnt(10)
    v_mfma_f32_32x32x16_bf16 v[48:63], a[16:19], v[168:171], v[48:63]
    ds_read_b64_tr_b16 a[4:5], v83 offset:3136
    ds_read_b64_tr_b16 a[6:7], v83 offset:3904
    s_waitcnt lgkmcnt(10)
    v_mfma_f32_32x32x16_bf16 v[64:79], a[20:23], v[168:171], v[64:79]
    ds_read_b64_tr_b16 a[8:9], v83 offset:3200
    ds_read_b64_tr_b16 a[10:11], v83 offset:3968
    s_waitcnt lgkmcnt(10)
    v_mfma_f32_32x32x16_bf16 v[32:47], a[24:27], v[172:175], v[32:47]
    ds_read_b64_tr_b16 a[12:13], v83 offset:44032
    ds_read_b64_tr_b16 a[14:15], v83 offset:44800
    ds_read_b64_tr_b16 a[36:37], v22 offset:3072
    ds_read_b64_tr_b16 a[38:39], v22 offset:3840
    s_waitcnt lgkmcnt(12)
    v_mfma_f32_32x32x16_bf16 v[48:63], a[28:31], v[172:175], v[48:63]
    ds_read_b64_tr_b16 a[16:17], v83 offset:44096
    ds_read_b64_tr_b16 a[18:19], v83 offset:44864
    ds_read_b64_tr_b16 a[40:41], v22 offset:3136
    ds_read_b64_tr_b16 a[42:43], v22 offset:3904
    s_waitcnt lgkmcnt(14)
    v_mfma_f32_32x32x16_bf16 v[64:79], a[32:35], v[172:175], v[64:79]
    ds_read_b64_tr_b16 a[20:21], v83 offset:44160
    ds_read_b64_tr_b16 a[22:23], v83 offset:44928
    ds_read_b64_tr_b16 a[44:45], v22 offset:3200
    ds_read_b64_tr_b16 a[46:47], v22 offset:3968
    s_waitcnt lgkmcnt(15)
    v_mfma_f32_32x32x16_bf16 v[32:47], a[0:3], v[176:179], v[32:47]
    ds_read_b64_tr_b16 a[24:25], v84 offset:19456
    ds_read_b64_tr_b16 a[26:27], v84 offset:20224
    s_waitcnt lgkmcnt(15)
    v_mfma_f32_32x32x16_bf16 v[48:63], a[4:7], v[176:179], v[48:63]
    ds_read_b64_tr_b16 a[28:29], v84 offset:19520
    ds_read_b64_tr_b16 a[30:31], v84 offset:20288
    s_waitcnt lgkmcnt(15)
    v_mfma_f32_32x32x16_bf16 v[64:79], a[8:11], v[176:179], v[64:79]
    ds_read_b64_tr_b16 a[32:33], v84 offset:19584
    ds_read_b64_tr_b16 a[34:35], v84 offset:20352
    s_waitcnt lgkmcnt(15)
    v_mfma_f32_32x32x16_bf16 v[32:47], a[12:15], v[180:183], v[32:47]
    ds_read_b64_tr_b16 a[0:1], v84 offset:60416
    ds_read_b64_tr_b16 a[2:3], v84 offset:61184
    s_waitcnt lgkmcnt(15)
    v_mfma_f32_16x16x32_bf16 v[96:99], a[36:39], v[92:95], v[96:99]
    s_waitcnt lgkmcnt(14)
    v_mfma_f32_32x32x16_bf16 v[48:63], a[16:19], v[180:183], v[48:63]
    ds_read_b64_tr_b16 a[4:5], v84 offset:60480
    ds_read_b64_tr_b16 a[6:7], v84 offset:61248
    s_waitcnt lgkmcnt(14)
    v_mfma_f32_16x16x32_bf16 v[100:103], a[40:43], v[92:95], v[100:103]
    s_waitcnt lgkmcnt(12)
    v_mfma_f32_32x32x16_bf16 v[64:79], a[20:23], v[180:183], v[64:79]
    ds_read_b64_tr_b16 a[8:9], v84 offset:60544
    ds_read_b64_tr_b16 a[10:11], v84 offset:61312
    s_waitcnt lgkmcnt(12)
    v_mfma_f32_16x16x32_bf16 v[104:107], a[44:47], v[92:95], v[104:107]
    s_waitcnt lgkmcnt(10)
    v_mfma_f32_32x32x16_bf16 v[32:47], a[24:27], v[184:187], v[32:47]
    s_waitcnt vmcnt(13)
    s_barrier
    ds_read_b64_tr_b16 a[12:13], v83 offset:6144
    ds_read_b64_tr_b16 a[14:15], v83 offset:6912
    s_waitcnt lgkmcnt(10)
    v_mfma_f32_32x32x16_bf16 v[48:63], a[28:31], v[184:187], v[48:63]
    ds_read_b64_tr_b16 a[16:17], v83 offset:6208
    ds_read_b64_tr_b16 a[18:19], v83 offset:6976
    s_waitcnt lgkmcnt(10)
    v_mfma_f32_32x32x16_bf16 v[64:79], a[32:35], v[184:187], v[64:79]
    ds_read_b64_tr_b16 a[20:21], v83 offset:6272
    ds_read_b64_tr_b16 a[22:23], v83 offset:7040
    s_waitcnt lgkmcnt(10)
    v_mfma_f32_32x32x16_bf16 v[32:47], a[0:3], v[188:191], v[32:47]
    ds_read_b64_tr_b16 a[24:25], v83 offset:47104
    ds_read_b64_tr_b16 a[26:27], v83 offset:47872
    ds_read_b64_tr_b16 a[36:37], v22 offset:6144
    ds_read_b64_tr_b16 a[38:39], v22 offset:6912
    s_waitcnt lgkmcnt(12)
    v_mfma_f32_32x32x16_bf16 v[48:63], a[4:7], v[188:191], v[48:63]
    ds_read_b64_tr_b16 a[28:29], v83 offset:47168
    ds_read_b64_tr_b16 a[30:31], v83 offset:47936
    ds_read_b64_tr_b16 a[40:41], v22 offset:6208
    ds_read_b64_tr_b16 a[42:43], v22 offset:6976
    s_waitcnt lgkmcnt(14)
    v_mfma_f32_32x32x16_bf16 v[64:79], a[8:11], v[188:191], v[64:79]
    ds_read_b64_tr_b16 a[32:33], v83 offset:47232
    ds_read_b64_tr_b16 a[34:35], v83 offset:48000
    ds_read_b64_tr_b16 a[44:45], v22 offset:6272
    ds_read_b64_tr_b16 a[46:47], v22 offset:7040
    s_waitcnt lgkmcnt(15)
    v_mfma_f32_32x32x16_bf16 v[32:47], a[12:15], v[192:195], v[32:47]
    ds_read_b64_tr_b16 a[0:1], v84 offset:22528
    ds_read_b64_tr_b16 a[2:3], v84 offset:23296
    s_waitcnt lgkmcnt(15)
    v_mfma_f32_32x32x16_bf16 v[48:63], a[16:19], v[192:195], v[48:63]
    ds_read_b64_tr_b16 a[4:5], v84 offset:22592
    ds_read_b64_tr_b16 a[6:7], v84 offset:23360
    s_waitcnt lgkmcnt(15)
    v_mfma_f32_32x32x16_bf16 v[64:79], a[20:23], v[192:195], v[64:79]
    ds_read_b64_tr_b16 a[8:9], v84 offset:22656
    ds_read_b64_tr_b16 a[10:11], v84 offset:23424
    s_waitcnt lgkmcnt(15)
    v_mfma_f32_32x32x16_bf16 v[32:47], a[24:27], v[196:199], v[32:47]
    ds_read_b64_tr_b16 a[12:13], v84 offset:63488
    ds_read_b64_tr_b16 a[14:15], v84 offset:64256
    s_waitcnt lgkmcnt(15)
    v_mfma_f32_16x16x32_bf16 v[96:99], a[36:39], v[92:95], v[96:99]
    s_waitcnt lgkmcnt(14)
    v_mfma_f32_32x32x16_bf16 v[48:63], a[28:31], v[196:199], v[48:63]
    ds_read_b64_tr_b16 a[16:17], v84 offset:63552
    ds_read_b64_tr_b16 a[18:19], v84 offset:64320
    s_waitcnt lgkmcnt(14)
    v_mfma_f32_16x16x32_bf16 v[100:103], a[40:43], v[92:95], v[100:103]
    s_waitcnt lgkmcnt(12)
    v_mfma_f32_32x32x16_bf16 v[64:79], a[32:35], v[196:199], v[64:79]
    ds_read_b64_tr_b16 a[20:21], v84 offset:63616
    ds_read_b64_tr_b16 a[22:23], v84 offset:64384
    s_waitcnt lgkmcnt(12)
    v_mfma_f32_16x16x32_bf16 v[104:107], a[44:47], v[92:95], v[104:107]
    s_waitcnt lgkmcnt(10)
    v_mfma_f32_32x32x16_bf16 v[32:47], a[0:3], v[200:203], v[32:47]
    s_waitcnt vmcnt(10)
    s_barrier
    ds_read_b64_tr_b16 a[24:25], v83 offset:9216
    ds_read_b64_tr_b16 a[26:27], v83 offset:9984
    s_waitcnt lgkmcnt(10)
    v_mfma_f32_32x32x16_bf16 v[48:63], a[4:7], v[200:203], v[48:63]
    ds_read_b64_tr_b16 a[28:29], v83 offset:9280
    ds_read_b64_tr_b16 a[30:31], v83 offset:10048
    s_waitcnt lgkmcnt(10)
    v_mfma_f32_32x32x16_bf16 v[64:79], a[8:11], v[200:203], v[64:79]
    ds_read_b64_tr_b16 a[32:33], v83 offset:9344
    ds_read_b64_tr_b16 a[34:35], v83 offset:10112
    s_waitcnt lgkmcnt(10)
    v_mfma_f32_32x32x16_bf16 v[32:47], a[12:15], v[204:207], v[32:47]
    ds_read_b64_tr_b16 a[0:1], v83 offset:50176
    ds_read_b64_tr_b16 a[2:3], v83 offset:50944
    ds_read_b64_tr_b16 a[36:37], v22 offset:9216
    ds_read_b64_tr_b16 a[38:39], v22 offset:9984
    s_waitcnt lgkmcnt(12)
    v_mfma_f32_32x32x16_bf16 v[48:63], a[16:19], v[204:207], v[48:63]
    ds_read_b64_tr_b16 a[4:5], v83 offset:50240
    ds_read_b64_tr_b16 a[6:7], v83 offset:51008
    ds_read_b64_tr_b16 a[40:41], v22 offset:9280
    ds_read_b64_tr_b16 a[42:43], v22 offset:10048
    s_waitcnt lgkmcnt(14)
    v_mfma_f32_32x32x16_bf16 v[64:79], a[20:23], v[204:207], v[64:79]
    ds_read_b64_tr_b16 a[8:9], v83 offset:50304
    ds_read_b64_tr_b16 a[10:11], v83 offset:51072
    ds_read_b64_tr_b16 a[44:45], v22 offset:9344
    ds_read_b64_tr_b16 a[46:47], v22 offset:10112
    s_waitcnt lgkmcnt(15)
    v_mfma_f32_32x32x16_bf16 v[32:47], a[24:27], v[208:211], v[32:47]
    ds_read_b64_tr_b16 a[12:13], v84 offset:25600
    ds_read_b64_tr_b16 a[14:15], v84 offset:26368
    s_waitcnt lgkmcnt(15)
    v_mfma_f32_32x32x16_bf16 v[48:63], a[28:31], v[208:211], v[48:63]
    ds_read_b64_tr_b16 a[16:17], v84 offset:25664
    ds_read_b64_tr_b16 a[18:19], v84 offset:26432
    s_waitcnt lgkmcnt(15)
    v_mfma_f32_32x32x16_bf16 v[64:79], a[32:35], v[208:211], v[64:79]
    ds_read_b64_tr_b16 a[20:21], v84 offset:25728
    ds_read_b64_tr_b16 a[22:23], v84 offset:26496
    s_waitcnt lgkmcnt(15)
    v_mfma_f32_32x32x16_bf16 v[32:47], a[0:3], v[212:215], v[32:47]
    ds_read_b64_tr_b16 a[24:25], v85 offset:1024
    ds_read_b64_tr_b16 a[26:27], v85 offset:1792
    s_waitcnt lgkmcnt(15)
    v_mfma_f32_16x16x32_bf16 v[96:99], a[36:39], v[92:95], v[96:99]
    s_waitcnt lgkmcnt(14)
    v_mfma_f32_32x32x16_bf16 v[48:63], a[4:7], v[212:215], v[48:63]
    ds_read_b64_tr_b16 a[28:29], v85 offset:1088
    ds_read_b64_tr_b16 a[30:31], v85 offset:1856
    s_waitcnt lgkmcnt(14)
    v_mfma_f32_16x16x32_bf16 v[100:103], a[40:43], v[92:95], v[100:103]
    s_waitcnt lgkmcnt(12)
    v_mfma_f32_32x32x16_bf16 v[64:79], a[8:11], v[212:215], v[64:79]
    ds_read_b64_tr_b16 a[32:33], v85 offset:1152
    ds_read_b64_tr_b16 a[34:35], v85 offset:1920
    s_waitcnt lgkmcnt(12)
    v_mfma_f32_16x16x32_bf16 v[104:107], a[44:47], v[92:95], v[104:107]
    s_waitcnt lgkmcnt(10)
    v_mfma_f32_32x32x16_bf16 v[32:47], a[12:15], v[216:219], v[32:47]
    s_waitcnt vmcnt(7)
    s_barrier
    ds_read_b64_tr_b16 a[0:1], v83 offset:12288
    ds_read_b64_tr_b16 a[2:3], v83 offset:13056
    s_waitcnt lgkmcnt(10)
    v_mfma_f32_32x32x16_bf16 v[48:63], a[16:19], v[216:219], v[48:63]
    ds_read_b64_tr_b16 a[4:5], v83 offset:12352
    ds_read_b64_tr_b16 a[6:7], v83 offset:13120
    s_waitcnt lgkmcnt(10)
    v_mfma_f32_32x32x16_bf16 v[64:79], a[20:23], v[216:219], v[64:79]
    ds_read_b64_tr_b16 a[8:9], v83 offset:12416
    ds_read_b64_tr_b16 a[10:11], v83 offset:13184
    s_waitcnt lgkmcnt(10)
    v_mfma_f32_32x32x16_bf16 v[32:47], a[24:27], v[220:223], v[32:47]
    ds_read_b64_tr_b16 a[12:13], v83 offset:53248
    ds_read_b64_tr_b16 a[14:15], v83 offset:54016
    ds_read_b64_tr_b16 a[36:37], v22 offset:12288
    ds_read_b64_tr_b16 a[38:39], v22 offset:13056
    s_waitcnt lgkmcnt(12)
    v_mfma_f32_32x32x16_bf16 v[48:63], a[28:31], v[220:223], v[48:63]
    buffer_load_dwordx2 v[8:9], v23, s[28:31], 0 offen sc1
    ds_read_b64_tr_b16 a[16:17], v83 offset:53312
    ds_read_b64_tr_b16 a[18:19], v83 offset:54080
    ds_read_b64_tr_b16 a[40:41], v22 offset:12352
    ds_read_b64_tr_b16 a[42:43], v22 offset:13120
    s_waitcnt lgkmcnt(14)
    v_mfma_f32_32x32x16_bf16 v[64:79], a[32:35], v[220:223], v[64:79]
    ds_read_b64_tr_b16 a[20:21], v83 offset:53376
    ds_read_b64_tr_b16 a[22:23], v83 offset:54144
    ds_read_b64_tr_b16 a[44:45], v22 offset:12416
    ds_read_b64_tr_b16 a[46:47], v22 offset:13184
    s_waitcnt lgkmcnt(15)
    v_mfma_f32_32x32x16_bf16 v[32:47], a[0:3], v[224:227], v[32:47]
    ds_read_b64_tr_b16 a[24:25], v84 offset:28672
    ds_read_b64_tr_b16 a[26:27], v84 offset:29440
    s_waitcnt lgkmcnt(15)
    v_mfma_f32_32x32x16_bf16 v[48:63], a[4:7], v[224:227], v[48:63]
    ds_read_b64_tr_b16 a[28:29], v84 offset:28736
    ds_read_b64_tr_b16 a[30:31], v84 offset:29504
    s_waitcnt lgkmcnt(15)
    v_mfma_f32_32x32x16_bf16 v[64:79], a[8:11], v[224:227], v[64:79]
    ds_read_b64_tr_b16 a[32:33], v84 offset:28800
    ds_read_b64_tr_b16 a[34:35], v84 offset:29568
    s_waitcnt lgkmcnt(15)
    v_mfma_f32_32x32x16_bf16 v[32:47], a[12:15], v[228:231], v[32:47]
    ds_read_b64_tr_b16 a[0:1], v85 offset:4096
    ds_read_b64_tr_b16 a[2:3], v85 offset:4864
    s_add_u32 m0, s7, 16384
    s_nop 0
    buffer_load_dwordx4 v12, s[12:15], s72 offen lds
    s_waitcnt lgkmcnt(15)
    v_mfma_f32_16x16x32_bf16 v[96:99], a[36:39], v[92:95], v[96:99]
    s_waitcnt lgkmcnt(14)
    v_mfma_f32_32x32x16_bf16 v[48:63], a[16:19], v[228:231], v[48:63]
    ds_read_b64_tr_b16 a[4:5], v85 offset:4160
    ds_read_b64_tr_b16 a[6:7], v85 offset:4928
    s_waitcnt lgkmcnt(14)
    v_mfma_f32_16x16x32_bf16 v[100:103], a[40:43], v[92:95], v[100:103]
    s_waitcnt lgkmcnt(12)
    v_mfma_f32_32x32x16_bf16 v[64:79], a[20:23], v[228:231], v[64:79]
    ds_read_b64_tr_b16 a[8:9], v85 offset:4224
    ds_read_b64_tr_b16 a[10:11], v85 offset:4992
    s_add_u32 m0, s7, 17408
    s_nop 0
    buffer_load_dwordx4 v12, s[12:15], s73 offen lds
    s_waitcnt lgkmcnt(12)
    v_mfma_f32_16x16x32_bf16 v[104:107], a[44:47], v[92:95], v[104:107]
    s_waitcnt lgkmcnt(10)
    v_mfma_f32_32x32x16_bf16 v[32:47], a[24:27], v[232:235], v[32:47]
    s_waitcnt vmcnt(7)
    s_barrier
    ds_read_b64_tr_b16 a[12:13], v83 offset:24576
    ds_read_b64_tr_b16 a[14:15], v83 offset:25344
    s_waitcnt lgkmcnt(10)
    v_mfma_f32_32x32x16_bf16 v[48:63], a[28:31], v[232:235], v[48:63]
    ds_read_b64_tr_b16 a[16:17], v83 offset:24640
    ds_read_b64_tr_b16 a[18:19], v83 offset:25408
    s_waitcnt lgkmcnt(10)
    v_mfma_f32_32x32x16_bf16 v[64:79], a[32:35], v[232:235], v[64:79]
    ds_read_b64_tr_b16 a[20:21], v83 offset:24704
    ds_read_b64_tr_b16 a[22:23], v83 offset:25472
    s_add_u32 m0, s7, 18432
    s_nop 0
    buffer_load_dwordx4 v12, s[12:15], s74 offen lds
    s_waitcnt lgkmcnt(10)
    v_mfma_f32_32x32x16_bf16 v[32:47], a[0:3], v[236:239], v[32:47]
    ds_read_b64_tr_b16 a[24:25], v84 offset:0
    ds_read_b64_tr_b16 a[26:27], v84 offset:768
    ds_read_b64_tr_b16 a[36:37], v22 offset:24576
    ds_read_b64_tr_b16 a[38:39], v22 offset:25344
    s_waitcnt lgkmcnt(12)
    v_mfma_f32_32x32x16_bf16 v[48:63], a[4:7], v[236:239], v[48:63]
    ds_read_b64_tr_b16 a[28:29], v84 offset:64
    ds_read_b64_tr_b16 a[30:31], v84 offset:832
    ds_read_b64_tr_b16 a[40:41], v22 offset:24640
    ds_read_b64_tr_b16 a[42:43], v22 offset:25408
    s_waitcnt lgkmcnt(14)
    v_mfma_f32_32x32x16_bf16 v[64:79], a[8:11], v[236:239], v[64:79]
    ds_read_b64_tr_b16 a[32:33], v84 offset:128
    ds_read_b64_tr_b16 a[34:35], v84 offset:896
    ds_read_b64_tr_b16 a[44:45], v22 offset:24704
    ds_read_b64_tr_b16 a[46:47], v22 offset:25472
    s_waitcnt lgkmcnt(15)
    v_mfma_f32_32x32x16_bf16 v[32:47], a[12:15], v[240:243], v[32:47]
    ds_read_b64_tr_b16 a[0:1], v84 offset:40960
    ds_read_b64_tr_b16 a[2:3], v84 offset:41728
    s_add_u32 m0, s7, 19456
    s_nop 0
    buffer_load_dwordx4 v12, s[12:15], s75 offen lds
    s_waitcnt lgkmcnt(10)
    v_mfma_f32_16x16x32_bf16 v[96:99], a[36:39], v[92:95], v[96:99]
    v_mfma_f32_32x32x16_bf16 v[48:63], a[16:19], v[240:243], v[48:63]
    ds_read_b64_tr_b16 a[4:5], v84 offset:41024
    ds_read_b64_tr_b16 a[6:7], v84 offset:41792
    s_waitcnt lgkmcnt(8)
    v_mfma_f32_16x16x32_bf16 v[100:103], a[40:43], v[92:95], v[100:103]
    v_mfma_f32_32x32x16_bf16 v[64:79], a[20:23], v[240:243], v[64:79]
    ds_read_b64_tr_b16 a[8:9], v84 offset:41088
    ds_read_b64_tr_b16 a[10:11], v84 offset:41856
    s_add_u32 m0, s7, 20480
    s_nop 0
    buffer_load_dwordx4 v12, s[12:15], s76 offen lds
    s_waitcnt lgkmcnt(6)
    v_mfma_f32_16x16x32_bf16 v[104:107], a[44:47], v[92:95], v[104:107]
    v_mfma_f32_32x32x16_bf16 v[32:47], a[24:27], v[244:247], v[32:47]
    ds_read_b64_tr_b16 a[12:13], v85 offset:16384
    ds_read_b64_tr_b16 a[14:15], v85 offset:17152
    v_mfma_f32_32x32x16_bf16 v[48:63], a[28:31], v[244:247], v[48:63]
    ds_read_b64_tr_b16 a[16:17], v85 offset:16448
    ds_read_b64_tr_b16 a[18:19], v85 offset:17216
    s_mov_b32 exec_lo, 0x00030003
    s_mov_b32 exec_hi, 0x00030003
    ds_write_b128 v5, v[96:99]
    ds_write_b128 v5, v[100:103] offset:40960
    ds_write_b128 v17, v[104:107]
    s_mov_b64 exec, -1
    v_mfma_f32_32x32x16_bf16 v[64:79], a[32:35], v[244:247], v[64:79]
    ds_read_b64_tr_b16 a[20:21], v85 offset:16512
    ds_read_b64_tr_b16 a[22:23], v85 offset:17280
    s_add_u32 m0, s7, 21504
    s_nop 0
    buffer_load_dwordx4 v12, s[12:15], s77 offen lds
    s_waitcnt lgkmcnt(13)
    v_mfma_f32_32x32x16_bf16 v[32:47], a[0:3], v[248:251], v[32:47]
    s_waitcnt lgkmcnt(2)
    s_barrier
    ds_read2_b32 v[108:109], v10 offset0:0 offset1:32
    ds_read2_b32 v[110:111], v10 offset0:64 offset1:96
    v_mfma_f32_32x32x16_bf16 v[48:63], a[4:7], v[248:251], v[48:63]
    ds_read2_b32 v[112:113], v89 offset0:0 offset1:32
    ds_read2_b32 v[114:115], v89 offset0:64 offset1:96
    v_mfma_f32_32x32x16_bf16 v[64:79], a[8:11], v[248:251], v[64:79]
    ds_read2_b32 v[116:117], v90 offset0:0 offset1:32
    ds_read2_b32 v[118:119], v90 offset0:64 offset1:96
    v_mfma_f32_32x32x16_bf16 v[32:47], a[12:15], v[252:255], v[32:47]
    s_add_u32 m0, s7, 22528
    s_nop 0
    buffer_load_dwordx4 v12, s[12:15], s78 offen lds
    ds_read_u16 v97, v15 offset:40448
    ds_read_u16 v101, v15 offset:40512
    v_mfma_f32_32x32x16_bf16 v[48:63], a[16:19], v[252:255], v[48:63]
    ds_read_u16 v105, v15 offset:40576
    s_waitcnt lgkmcnt(8)
    v_add_f32 v108, v108, v109
    s_waitcnt lgkmcnt(7)
    v_add_f32 v110, v110, v111
    v_add_f32 v108, v108, v110
    v_cvt_pk_bf16_f32 v109, v108, v108
    v_lshlrev_b32_e64 v109, 16, v109
    v_mfma_f32_32x32x16_bf16 v[64:79], a[20:23], v[252:255], v[64:79]
    v_sub_f32_e64 v109, v108, v109
    v_cvt_pk_bf16_f32 v96, v108, v109
    v_mov_b64 v[98:99], 0
    s_waitcnt lgkmcnt(6)
    v_add_f32 v112, v112, v113
    s_waitcnt lgkmcnt(5)
    v_add_f32 v114, v114, v115
    v_add_f32 v112, v112, v114
    v_cvt_pk_bf16_f32 v113, v112, v112
    v_lshlrev_b32 v113, 16, v113
    v_sub_f32 v113, v112, v113
    v_cvt_pk_bf16_f32 v100, v112, v113
    v_mov_b64 v[102:103], 0
    s_waitcnt lgkmcnt(4)
    v_add_f32 v116, v116, v117
    s_waitcnt lgkmcnt(3)
    v_add_f32 v118, v118, v119
    v_add_f32 v116, v116, v118
    v_cvt_pk_bf16_f32 v117, v116, v116
    v_lshlrev_b32 v117, 16, v117
    v_sub_f32 v117, v116, v117
    v_cvt_pk_bf16_f32 v104, v116, v117
    v_mov_b64 v[106:107], 0
    s_waitcnt lgkmcnt(2)
    v_mfma_f32_32x32x16_bf16 v[32:47], v[96:99], v[28:31], v[32:47]
    s_barrier
    s_waitcnt lgkmcnt(1)
    v_mfma_f32_32x32x16_bf16 v[48:63], v[100:103], v[28:31], v[48:63]
    s_add_u32 m0, s7, 23552
    s_nop 0
    buffer_load_dwordx4 v12, s[12:15], s79 offen lds
    s_waitcnt lgkmcnt(0)
    v_mfma_f32_32x32x16_bf16 v[64:79], v[104:107], v[28:31], v[64:79]
    s_waitcnt vmcnt(8)
    v_cmp_ne_u64 vcc, s[52:53], v[8:9]
    s_nop 0
    s_cmp_eq_u64 vcc, 0
    s_cbranch_scc0 Lpoll_3
Lpollb_4:
    v_pk_mul_f32 v[108:109], v[32:33], v[32:33]
    v_pk_mul_f32 v[110:111], v[34:35], v[34:35]
    v_pk_fma_f32 v[108:109], v[108:109], v[16:17], v[14:15] op_sel_hi:[1,0,0]
    v_pk_fma_f32 v[110:111], v[110:111], v[16:17], v[14:15] op_sel_hi:[1,0,0]
    v_pk_mul_f32 v[108:109], v[32:33], v[108:109]
    v_pk_mul_f32 v[110:111], v[34:35], v[110:111]
    v_exp_f32 v108, v108
    v_exp_f32 v109, v109
    v_exp_f32 v110, v110
    v_exp_f32_e64 v111, v111
    v_pk_fma_f32 v[108:109], v[108:109], v[18:19], v[18:19] op_sel_hi:[1,0,0]
    v_pk_fma_f32 v[110:111], v[110:111], v[18:19], v[18:19] op_sel_hi:[1,0,0]
    v_rcp_f32 v108, v108
    v_rcp_f32 v109, v109
    v_rcp_f32 v110, v110
    v_rcp_f32 v111, v111
    v_pk_mul_f32 v[32:33], v[32:33], v[108:109]
    v_pk_mul_f32 v[34:35], v[34:35], v[110:111]
    v_cvt_pk_bf16_f32 v112, v32, v33
    v_cvt_pk_bf16_f32 v113, v34, v35
    v_pk_mul_f32 v[108:109], v[36:37], v[36:37]
    v_pk_mul_f32 v[110:111], v[38:39], v[38:39]
    v_pk_fma_f32 v[108:109], v[108:109], v[16:17], v[14:15] op_sel_hi:[1,0,0]
    v_pk_fma_f32 v[110:111], v[110:111], v[16:17], v[14:15] op_sel_hi:[1,0,0]
    v_pk_mul_f32 v[108:109], v[36:37], v[108:109]
    v_pk_mul_f32 v[110:111], v[38:39], v[110:111]
    v_exp_f32 v108, v108
    v_exp_f32 v109, v109
    v_exp_f32 v110, v110
    v_exp_f32 v111, v111
    v_pk_fma_f32 v[108:109], v[108:109], v[18:19], v[18:19] op_sel_hi:[1,0,0]
    v_pk_fma_f32 v[110:111], v[110:111], v[18:19], v[18:19] op_sel_hi:[1,0,0]
    v_rcp_f32 v108, v108
    v_rcp_f32 v109, v109
    v_rcp_f32 v110, v110
    v_rcp_f32 v111, v111
    v_pk_mul_f32 v[36:37], v[36:37], v[108:109]
    v_pk_mul_f32 v[38:39], v[38:39], v[110:111]
    v_cvt_pk_bf16_f32 v114, v36, v37
    v_cvt_pk_bf16_f32 v115, v38, v39
    s_add_u32 s56, s60, 0
    buffer_store_dwordx4 v[112:115], v24, s[36:39], s56 offen sc1
    v_pk_mul_f32 v[108:109], v[40:41], v[40:41]
    v_pk_mul_f32 v[110:111], v[42:43], v[42:43]
    v_pk_fma_f32 v[108:109], v[108:109], v[16:17], v[14:15] op_sel_hi:[1,0,0]
    v_pk_fma_f32 v[110:111], v[110:111], v[16:17], v[14:15] op_sel_hi:[1,0,0]
    v_pk_mul_f32 v[108:109], v[40:41], v[108:109]
    v_pk_mul_f32 v[110:111], v[42:43], v[110:111]
    v_exp_f32 v108, v108
    v_exp_f32 v109, v109
    v_exp_f32 v110, v110
    v_exp_f32_e64 v111, v111
    v_pk_fma_f32 v[108:109], v[108:109], v[18:19], v[18:19] op_sel_hi:[1,0,0]
    v_pk_fma_f32 v[110:111], v[110:111], v[18:19], v[18:19] op_sel_hi:[1,0,0]
    v_rcp_f32 v108, v108
    v_rcp_f32 v109, v109
    v_rcp_f32 v110, v110
    v_rcp_f32 v111, v111
    v_pk_mul_f32 v[40:41], v[40:41], v[108:109]
    v_pk_mul_f32 v[42:43], v[42:43], v[110:111]
    v_cvt_pk_bf16_f32 v116, v40, v41
    v_cvt_pk_bf16_f32 v117, v42, v43
    v_pk_mul_f32 v[108:109], v[44:45], v[44:45]
    v_pk_mul_f32 v[110:111], v[46:47], v[46:47]
    v_pk_fma_f32 v[108:109], v[108:109], v[16:17], v[14:15] op_sel_hi:[1,0,0]
    v_pk_fma_f32 v[110:111], v[110:111], v[16:17], v[14:15] op_sel_hi:[1,0,0]
    v_pk_mul_f32 v[108:109], v[44:45], v[108:109]
    v_pk_mul_f32 v[110:111], v[46:47], v[110:111]
    v_exp_f32 v108, v108
    v_exp_f32 v109, v109
    v_exp_f32 v110, v110
    v_exp_f32 v111, v111
    v_pk_fma_f32 v[108:109], v[108:109], v[18:19], v[18:19] op_sel_hi:[1,0,0]
    v_pk_fma_f32 v[110:111], v[110:111], v[18:19], v[18:19] op_sel_hi:[1,0,0]
    v_rcp_f32 v108, v108
    v_rcp_f32 v109, v109
    v_rcp_f32 v110, v110
    v_rcp_f32 v111, v111
    v_pk_mul_f32 v[44:45], v[44:45], v[108:109]
    v_pk_mul_f32 v[46:47], v[46:47], v[110:111]
    v_cvt_pk_bf16_f32 v118, v44, v45
    v_cvt_pk_bf16_f32 v119, v46, v47
    s_add_u32 s56, s60, 2048
    buffer_store_dwordx4 v[116:119], v24, s[36:39], s56 offen sc1
    v_pk_mul_f32 v[108:109], v[48:49], v[48:49]
    v_pk_mul_f32 v[110:111], v[50:51], v[50:51]
    v_pk_fma_f32 v[108:109], v[108:109], v[16:17], v[14:15] op_sel_hi:[1,0,0]
    v_pk_fma_f32 v[110:111], v[110:111], v[16:17], v[14:15] op_sel_hi:[1,0,0]
    v_pk_mul_f32 v[108:109], v[48:49], v[108:109]
    v_pk_mul_f32 v[110:111], v[50:51], v[110:111]
    v_exp_f32 v108, v108
    v_exp_f32 v109, v109
    v_exp_f32 v110, v110
    v_exp_f32 v111, v111
    v_pk_fma_f32 v[108:109], v[108:109], v[18:19], v[18:19] op_sel_hi:[1,0,0]
    v_pk_fma_f32 v[110:111], v[110:111], v[18:19], v[18:19] op_sel_hi:[1,0,0]
    v_rcp_f32 v108, v108
    v_rcp_f32 v109, v109
    v_rcp_f32 v110, v110
    v_rcp_f32 v111, v111
    v_pk_mul_f32 v[48:49], v[48:49], v[108:109]
    v_pk_mul_f32 v[50:51], v[50:51], v[110:111]
    v_cvt_pk_bf16_f32 v112, v48, v49
    v_cvt_pk_bf16_f32 v113, v50, v51
    v_pk_mul_f32 v[108:109], v[52:53], v[52:53]
    v_pk_mul_f32 v[110:111], v[54:55], v[54:55]
    v_pk_fma_f32 v[108:109], v[108:109], v[16:17], v[14:15] op_sel_hi:[1,0,0]
    v_pk_fma_f32 v[110:111], v[110:111], v[16:17], v[14:15] op_sel_hi:[1,0,0]
    v_pk_mul_f32 v[108:109], v[52:53], v[108:109]
    v_pk_mul_f32 v[110:111], v[54:55], v[110:111]
    v_exp_f32 v108, v108
    v_exp_f32 v109, v109
    v_exp_f32 v110, v110
    v_exp_f32 v111, v111
    v_pk_fma_f32 v[108:109], v[108:109], v[18:19], v[18:19] op_sel_hi:[1,0,0]
    v_pk_fma_f32 v[110:111], v[110:111], v[18:19], v[18:19] op_sel_hi:[1,0,0]
    v_rcp_f32 v108, v108
    v_rcp_f32 v109, v109
    v_rcp_f32 v110, v110
    v_rcp_f32 v111, v111
    v_pk_mul_f32 v[52:53], v[52:53], v[108:109]
    v_pk_mul_f32 v[54:55], v[54:55], v[110:111]
    v_cvt_pk_bf16_f32 v114, v52, v53
    v_cvt_pk_bf16_f32 v115, v54, v55
    s_add_u32 s56, s60, 4096
    buffer_store_dwordx4 v[112:115], v24, s[36:39], s56 offen sc1
    v_pk_mul_f32 v[108:109], v[56:57], v[56:57]
    v_pk_mul_f32 v[110:111], v[58:59], v[58:59]
    v_pk_fma_f32 v[108:109], v[108:109], v[16:17], v[14:15] op_sel_hi:[1,0,0]
    v_pk_fma_f32 v[110:111], v[110:111], v[16:17], v[14:15] op_sel_hi:[1,0,0]
    v_pk_mul_f32 v[108:109], v[56:57], v[108:109]
    v_pk_mul_f32 v[110:111], v[58:59], v[110:111]
    v_exp_f32 v108, v108
    v_exp_f32 v109, v109
    v_exp_f32 v110, v110
    v_exp_f32 v111, v111
    v_pk_fma_f32 v[108:109], v[108:109], v[18:19], v[18:19] op_sel_hi:[1,0,0]
    v_pk_fma_f32 v[110:111], v[110:111], v[18:19], v[18:19] op_sel_hi:[1,0,0]
    v_rcp_f32 v108, v108
    v_rcp_f32 v109, v109
    v_rcp_f32 v110, v110
    v_rcp_f32 v111, v111
    v_pk_mul_f32 v[56:57], v[56:57], v[108:109]
    v_pk_mul_f32 v[58:59], v[58:59], v[110:111]
    v_cvt_pk_bf16_f32 v116, v56, v57
    v_cvt_pk_bf16_f32 v117, v58, v59
    v_pk_mul_f32 v[108:109], v[60:61], v[60:61]
    v_pk_mul_f32 v[110:111], v[62:63], v[62:63]
    v_pk_fma_f32 v[108:109], v[108:109], v[16:17], v[14:15] op_sel_hi:[1,0,0]
    v_pk_fma_f32 v[110:111], v[110:111], v[16:17], v[14:15] op_sel_hi:[1,0,0]
    v_pk_mul_f32 v[108:109], v[60:61], v[108:109]
    v_pk_mul_f32 v[110:111], v[62:63], v[110:111]
    v_exp_f32 v108, v108
    v_exp_f32 v109, v109
    v_exp_f32 v110, v110
    v_exp_f32 v111, v111
    v_pk_fma_f32 v[108:109], v[108:109], v[18:19], v[18:19] op_sel_hi:[1,0,0]
    v_pk_fma_f32 v[110:111], v[110:111], v[18:19], v[18:19] op_sel_hi:[1,0,0]
    v_rcp_f32 v108, v108
    v_rcp_f32 v109, v109
    v_rcp_f32 v110, v110
    v_rcp_f32 v111, v111
    v_pk_mul_f32 v[60:61], v[60:61], v[108:109]
    v_pk_mul_f32 v[62:63], v[62:63], v[110:111]
    v_cvt_pk_bf16_f32 v118, v60, v61
    v_cvt_pk_bf16_f32 v119, v62, v63
    s_add_u32 s56, s60, 6144
    buffer_store_dwordx4 v[116:119], v24, s[36:39], s56 offen sc1
    v_pk_mul_f32 v[108:109], v[64:65], v[64:65]
    v_pk_mul_f32 v[110:111], v[66:67], v[66:67]
    v_pk_fma_f32 v[108:109], v[108:109], v[16:17], v[14:15] op_sel_hi:[1,0,0]
    v_pk_fma_f32 v[110:111], v[110:111], v[16:17], v[14:15] op_sel_hi:[1,0,0]
    v_pk_mul_f32 v[108:109], v[64:65], v[108:109]
    v_pk_mul_f32 v[110:111], v[66:67], v[110:111]
    v_exp_f32_e64 v108, v108
    s_add_u32 m0, s7, 0
    s_nop 0
    buffer_load_dwordx4 v121, s[32:35], s64 offen offset:0 sc1 lds
    v_exp_f32 v109, v109
    v_exp_f32 v110, v110
    s_add_u32 m0, s7, 32
    s_nop 0
    buffer_load_dwordx4 v121, s[32:35], s64 offen offset:1024 sc1 lds
    v_exp_f32_e64 v111, v111
    v_pk_fma_f32 v[108:109], v[108:109], v[18:19], v[18:19] op_sel_hi:[1,0,0]
    v_pk_fma_f32 v[110:111], v[110:111], v[18:19], v[18:19] op_sel_hi:[1,0,0]
    v_rcp_f32 v108, v108
    v_rcp_f32 v109, v109
    v_rcp_f32_e64 v110, v110
    s_add_u32 m0, s7, 64
    s_nop 0
    buffer_load_dwordx4 v24, s[32:35], s65 offen offset:2048 sc1 lds
    v_rcp_f32_e64 v111, v111
    v_pk_mul_f32 v[64:65], v[64:65], v[108:109]
    v_pk_mul_f32 v[66:67], v[66:67], v[110:111]
    v_cvt_pk_bf16_f32 v112, v64, v65
    v_cvt_pk_bf16_f32 v113, v66, v67
    v_pk_mul_f32 v[108:109], v[68:69], v[68:69]
    v_pk_mul_f32 v[110:111], v[70:71], v[70:71]
    v_pk_fma_f32 v[108:109], v[108:109], v[16:17], v[14:15] op_sel_hi:[1,0,0]
    v_pk_fma_f32 v[110:111], v[110:111], v[16:17], v[14:15] op_sel_hi:[1,0,0]
    v_pk_mul_f32 v[108:109], v[68:69], v[108:109]
    s_add_u32 m0, s7, 96
    s_nop 0
    buffer_load_dwordx4 v24, s[32:35], s65 offen offset:3072 sc1 lds
    v_pk_mul_f32 v[110:111], v[70:71], v[110:111]
    v_exp_f32 v108, v108
    v_exp_f32 v109, v109
    v_exp_f32 v110, v110
    v_exp_f32_e64 v111, v111
    v_pk_fma_f32 v[108:109], v[108:109], v[18:19], v[18:19] op_sel_hi:[1,0,0]
    v_pk_fma_f32 v[110:111], v[110:111], v[18:19], v[18:19] op_sel_hi:[1,0,0]
    s_add_u32 m0, s7, 4224
    s_nop 0
    buffer_load_dwordx4 v122, s[32:35], s66 offen offset:0 sc1 lds
    v_rcp_f32 v108, v108
    v_rcp_f32 v109, v109
    v_rcp_f32 v110, v110
    v_rcp_f32_e64 v111, v111
    v_pk_mul_f32 v[68:69], v[68:69], v[108:109]
    v_pk_mul_f32 v[70:71], v[70:71], v[110:111]
    v_cvt_pk_bf16_f32 v114, v68, v69
    s_add_u32 m0, s7, 4256
    s_nop 0
    buffer_load_dwordx4 v122, s[32:35], s66 offen offset:1024 sc1 lds
    v_cvt_pk_bf16_f32 v115, v70, v71
    s_add_u32 s56, s60, 8192
    buffer_store_dwordx4 v[112:115], v24, s[36:39], s56 offen sc1
    v_pk_mul_f32 v[108:109], v[72:73], v[72:73]
    v_pk_mul_f32 v[110:111], v[74:75], v[74:75]
    v_pk_fma_f32 v[108:109], v[108:109], v[16:17], v[14:15] op_sel_hi:[1,0,0]
    v_pk_fma_f32 v[110:111], v[110:111], v[16:17], v[14:15] op_sel_hi:[1,0,0]
    v_pk_mul_f32 v[108:109], v[72:73], v[108:109]
    v_pk_mul_f32 v[110:111], v[74:75], v[110:111]
    v_exp_f32 v108, v108
    v_exp_f32 v109, v109
    v_exp_f32 v110, v110
    v_exp_f32_e64 v111, v111
    v_pk_fma_f32 v[108:109], v[108:109], v[18:19], v[18:19] op_sel_hi:[1,0,0]
    v_pk_fma_f32 v[110:111], v[110:111], v[18:19], v[18:19] op_sel_hi:[1,0,0]
    v_rcp_f32 v108, v108
    v_rcp_f32 v109, v109
    v_rcp_f32_e64 v110, v110
    s_add_u32 m0, s7, 4288
    s_nop 0
    buffer_load_dwordx4 v24, s[32:35], s67 offen offset:2048 sc1 lds
    v_rcp_f32 v111, v111
    v_pk_mul_f32 v[72:73], v[72:73], v[108:109]
    v_pk_mul_f32 v[74:75], v[74:75], v[110:111]
    v_cvt_pk_bf16_f32 v116, v72, v73
    v_cvt_pk_bf16_f32 v117, v74, v75
    v_pk_mul_f32 v[108:109], v[76:77], v[76:77]
    v_pk_mul_f32 v[110:111], v[78:79], v[78:79]
    v_pk_fma_f32 v[108:109], v[108:109], v[16:17], v[14:15] op_sel_hi:[1,0,0]
    v_pk_fma_f32 v[110:111], v[110:111], v[16:17], v[14:15] op_sel_hi:[1,0,0]
    s_add_u32 m0, s7, 4320
    s_nop 0
    buffer_load_dwordx4 v24, s[32:35], s67 offen offset:3072 sc1 lds
    v_pk_mul_f32 v[108:109], v[76:77], v[108:109]
    v_pk_mul_f32 v[110:111], v[78:79], v[110:111]
    v_exp_f32 v108, v108
    v_exp_f32 v109, v109
    v_exp_f32 v110, v110
    v_exp_f32_e64 v111, v111
    v_pk_fma_f32 v[108:109], v[108:109], v[18:19], v[18:19] op_sel_hi:[1,0,0]
    s_add_u32 m0, s7, 8448
    s_nop 0
    buffer_load_dwordx4 v123, s[32:35], s68 offen offset:0 sc1 lds
    v_pk_fma_f32 v[110:111], v[110:111], v[18:19], v[18:19] op_sel_hi:[1,0,0]
    v_rcp_f32 v108, v108
    v_rcp_f32 v109, v109
    v_rcp_f32 v110, v110
    v_rcp_f32_e64 v111, v111
    v_pk_mul_f32 v[76:77], v[76:77], v[108:109]
    v_pk_mul_f32 v[78:79], v[78:79], v[110:111]
    s_add_u32 m0, s7, 8480
    s_nop 0
    buffer_load_dwordx4 v123, s[32:35], s68 offen offset:1024 sc1 lds
    v_cvt_pk_bf16_f32 v118, v76, v77
    v_cvt_pk_bf16_f32 v119, v78, v79
    s_add_u32 s56, s60, 10240
    buffer_store_dwordx4 v[116:119], v24, s[36:39], s56 offen sc1
    s_waitcnt vmcnt(16)
    s_barrier
    ds_read_b64_tr_b16 a[0:1], v19 offset:16384
    ds_read_b64_tr_b16 a[2:3], v19 offset:16640
    ds_read_b64_tr_b16 a[4:5], v19 offset:57344
    ds_read_b64_tr_b16 a[6:7], v19 offset:57600
    ds_read_b64_tr_b16 a[8:9], v20 offset:32768
    ds_read_b64_tr_b16 a[10:11], v20 offset:33024
    ds_read_b64_tr_b16 a[12:13], v21 offset:8192
    ds_read_b64_tr_b16 a[14:15], v21 offset:8448
    s_waitcnt lgkmcnt(6)
    v_mfma_f32_32x32x16_bf16 v[80:95], a[0:3], v[128:131], 0
    ds_read_b64_tr_b16 a[16:17], v19 offset:17408
    ds_read_b64_tr_b16 a[18:19], v19 offset:17664
    v_and_b32 v68, 11, v0
    v_min_u32 v68, 1, v68
    v_lshlrev_b32 v69, 4, v68
    s_waitcnt lgkmcnt(6)
    v_mfma_f32_32x32x16_bf16 v[80:95], a[4:7], v[132:135], v[80:95]
    ds_read_b64_tr_b16 a[20:21], v19 offset:58368
    ds_read_b64_tr_b16 a[22:23], v19 offset:58624
    s_add_u32 m0, s7, 8512
    s_nop 0
    buffer_load_dwordx4 v24, s[32:35], s69 offen offset:2048 sc1 lds
    s_waitcnt lgkmcnt(6)
    v_mfma_f32_32x32x16_bf16 v[80:95], a[8:11], v[136:139], v[80:95]
    ds_read_b64_tr_b16 a[24:25], v20 offset:33792
    ds_read_b64_tr_b16 a[26:27], v20 offset:34048
    v_and_b32 v68, 16, v0
    v_cmp_eq_u32 vcc, 0, v68
    v_add_u32 v68, 1024, v69
    s_waitcnt lgkmcnt(6)
    v_mfma_f32_32x32x16_bf16 v[80:95], a[12:15], v[140:143], v[80:95]
    ds_read_b64_tr_b16 a[28:29], v21 offset:9216
    ds_read_b64_tr_b16 a[30:31], v21 offset:9472
    s_add_u32 m0, s7, 8544
    s_nop 0
    buffer_load_dwordx4 v24, s[32:35], s69 offen offset:3072 sc1 lds
    s_waitcnt lgkmcnt(6)
    v_mfma_f32_32x32x16_bf16 v[80:95], a[16:19], v[144:147], v[80:95]
    ds_read_b64_tr_b16 a[0:1], v19 offset:18432
    ds_read_b64_tr_b16 a[2:3], v19 offset:18688
    ds_write_b32 v125, v126 offset:3136
    v_add_u32 v69, 256, v24
    v_cndmask_b32 v70, v68, v24, vcc
    s_waitcnt lgkmcnt(7)
    v_mfma_f32_32x32x16_bf16 v[80:95], a[20:23], v[148:151], v[80:95]
    ds_read_b64_tr_b16 a[4:5], v19 offset:59392
    ds_read_b64_tr_b16 a[6:7], v19 offset:59648
    s_add_u32 m0, s7, 30720
    s_add_u32 s96, s61, 0
    buffer_load_dwordx4 v1, s[20:23], s96 offen offset:0 lds
    buffer_load_dwordx4 v2, s[20:23], s96 offen offset:1024 lds
    s_waitcnt lgkmcnt(7)
    v_mfma_f32_32x32x16_bf16 v[80:95], a[24:27], v[152:155], v[80:95]
    ds_read_b64_tr_b16 a[8:9], v20 offset:34816
    ds_read_b64_tr_b16 a[10:11], v20 offset:35072
    v_cndmask_b32 v71, v68, v69, vcc
    s_add_u32 s54, s3, 0
    s_and_b32 s55, s54, 3
    s_waitcnt lgkmcnt(7)
    v_mfma_f32_32x32x16_bf16 v[80:95], a[28:31], v[156:159], v[80:95]
    ds_read_b64_tr_b16 a[12:13], v21 offset:10240
    ds_read_b64_tr_b16 a[14:15], v21 offset:10496
    s_mul_i32 s55, s55, 40960
    s_lshr_b32 s54, s54, 2
    s_mul_i32 s54, s54, 4224
    s_waitcnt lgkmcnt(7)
    v_mfma_f32_32x32x16_bf16 v[80:95], a[0:3], v[160:163], v[80:95]
    ds_read_b64_tr_b16 a[16:17], v19 offset:19456
    ds_read_b64_tr_b16 a[18:19], v19 offset:19712
    s_add_u32 s54, s54, s55
    v_add_u32 v60, s54, v24
    v_add_u32_e64 v112, s54, v70
    s_waitcnt lgkmcnt(6)
    v_mfma_f32_32x32x16_bf16 v[80:95], a[4:7], v[164:167], v[80:95]
    ds_read_b64_tr_b16 a[20:21], v19 offset:60416
    ds_read_b64_tr_b16 a[22:23], v19 offset:60672
    v_add_u32 v116, s54, v71
    s_add_u32 s54, s3, 1
    s_and_b32 s55, s54, 3
    s_waitcnt lgkmcnt(6)
    v_mfma_f32_32x32x16_bf16 v[80:95], a[8:11], v[168:171], v[80:95]
    ds_read_b64_tr_b16 a[24:25], v20 offset:35840
    ds_read_b64_tr_b16 a[26:27], v20 offset:36096
    s_mul_i32 s55, s55, 40960
    s_lshr_b32 s54, s54, 2
    s_mul_i32 s54, s54, 4224
    s_waitcnt lgkmcnt(6)
    v_mfma_f32_32x32x16_bf16 v[80:95], a[12:15], v[172:175], v[80:95]
    ds_read_b64_tr_b16 a[28:29], v21 offset:11264
    ds_read_b64_tr_b16 a[30:31], v21 offset:11520
    s_add_u32 s54, s54, s55
    v_add_u32 v61, s54, v24
    v_add_u32 v113, s54, v70
    s_waitcnt lgkmcnt(6)
    v_mfma_f32_32x32x16_bf16 v[80:95], a[16:19], v[176:179], v[80:95]
    ds_read_b64_tr_b16 a[0:1], v19 offset:20480
    ds_read_b64_tr_b16 a[2:3], v19 offset:20736
    v_add_u32 v117, s54, v71
    s_add_u32 s54, s3, 2
    s_and_b32 s55, s54, 3
    s_waitcnt lgkmcnt(6)
    v_mfma_f32_32x32x16_bf16 v[80:95], a[20:23], v[180:183], v[80:95]
    ds_read_b64_tr_b16 a[4:5], v19 offset:61440
    ds_read_b64_tr_b16 a[6:7], v19 offset:61696
    s_mul_i32 s55, s55, 40960
    s_lshr_b32 s54, s54, 2
    s_mul_i32 s54, s54, 4224
    s_waitcnt lgkmcnt(6)
    v_mfma_f32_32x32x16_bf16 v[80:95], a[24:27], v[184:187], v[80:95]
    ds_read_b64_tr_b16 a[8:9], v20 offset:36864
    ds_read_b64_tr_b16 a[10:11], v20 offset:37120
    s_add_u32 s54, s54, s55
    v_add_u32 v62, s54, v24
    v_add_u32 v114, s54, v70
    s_waitcnt lgkmcnt(6)
    v_mfma_f32_32x32x16_bf16 v[80:95], a[28:31], v[188:191], v[80:95]
    ds_read_b64_tr_b16 a[12:13], v21 offset:12288
    ds_read_b64_tr_b16 a[14:15], v21 offset:12544
    v_add_u32 v118, s54, v71
    s_add_u32 s54, s3, 3
    s_and_b32 s55, s54, 3
    s_waitcnt lgkmcnt(6)
    v_mfma_f32_32x32x16_bf16 v[80:95], a[0:3], v[192:195], v[80:95]
    ds_read_b64_tr_b16 a[16:17], v19 offset:21504
    ds_read_b64_tr_b16 a[18:19], v19 offset:21760
    s_mul_i32 s55, s55, 40960
    s_lshr_b32 s54, s54, 2
    s_mul_i32 s54, s54, 4224
    s_waitcnt lgkmcnt(6)
    v_mfma_f32_32x32x16_bf16 v[80:95], a[4:7], v[196:199], v[80:95]
    ds_read_b64_tr_b16 a[20:21], v19 offset:62464
    ds_read_b64_tr_b16 a[22:23], v19 offset:62720
    s_add_u32 s54, s54, s55
    v_add_u32 v63, s54, v24
    v_add_u32 v115, s54, v70
    s_waitcnt lgkmcnt(6)
    v_mfma_f32_32x32x16_bf16 v[80:95], a[8:11], v[200:203], v[80:95]
    ds_read_b64_tr_b16 a[24:25], v20 offset:37888
    ds_read_b64_tr_b16 a[26:27], v20 offset:38144
    s_add_u32 m0, s7, 32768
    s_add_u32 s96, s61, 16384
    buffer_load_dwordx4 v1, s[20:23], s96 offen offset:0 lds
    buffer_load_dwordx4 v2, s[20:23], s96 offen offset:1024 lds
    s_waitcnt lgkmcnt(6)
    v_mfma_f32_32x32x16_bf16 v[80:95], a[12:15], v[204:207], v[80:95]
    ds_read_b64_tr_b16 a[28:29], v21 offset:13312
    ds_read_b64_tr_b16 a[30:31], v21 offset:13568
    v_add_u32 v119, s54, v71
    v_and_b32 v68, 31, v0
    v_lshrrev_b32_e64 v69, 5, v0
    s_waitcnt lgkmcnt(6)
    v_mfma_f32_32x32x16_bf16 v[80:95], a[16:19], v[208:211], v[80:95]
    ds_read_b64_tr_b16 a[0:1], v19 offset:22528
    ds_read_b64_tr_b16 a[2:3], v19 offset:22784
    v_lshlrev_b32 v69, 2, v69
    v_sub_u32 v68, v68, v69
    v_mov_b32 v69, 0xffff
    s_waitcnt lgkmcnt(6)
    v_mfma_f32_32x32x16_bf16 v[80:95], a[20:23], v[212:215], v[80:95]
    ds_read_b64_tr_b16 a[4:5], v19 offset:63488
    ds_read_b64_tr_b16 a[6:7], v19 offset:63744
    v_mov_b32 v70, 0xffff0000
    v_cmp_gt_i32 s[64:65], 0, v68
    v_cmp_gt_i32 s[66:67], 1, v68
    s_waitcnt lgkmcnt(6)
    v_mfma_f32_32x32x16_bf16 v[80:95], a[24:27], v[216:219], v[80:95]
    ds_read_b64_tr_b16 a[8:9], v20 offset:38912
    ds_read_b64_tr_b16 a[10:11], v20 offset:39168
    s_add_u32 m0, s7, 34816
    s_add_u32 s96, s61, 32768
    buffer_load_dwordx4 v1, s[20:23], s96 offen offset:0 lds
    buffer_load_dwordx4 v2, s[20:23], s96 offen offset:1024 lds
    s_waitcnt lgkmcnt(6)
    v_mfma_f32_32x32x16_bf16 v[80:95], a[28:31], v[220:223], v[80:95]
    ds_read_b64_tr_b16 a[12:13], v21 offset:14336
    ds_read_b64_tr_b16 a[14:15], v21 offset:14592
    v_cmp_gt_i32 s[68:69], 2, v68
    v_cmp_gt_i32 s[70:71], 3, v68
    v_cmp_gt_i32 s[72:73], 8, v68
    s_waitcnt lgkmcnt(6)
    v_mfma_f32_32x32x16_bf16 v[80:95], a[0:3], v[224:227], v[80:95]
    ds_read_b64_tr_b16 a[16:17], v19 offset:23552
    ds_read_b64_tr_b16 a[18:19], v19 offset:23808
    v_cmp_gt_i32 s[74:75], 9, v68
    v_cmp_gt_i32 s[76:77], 10, v68
    v_cmp_gt_i32 s[78:79], 11, v68
    s_waitcnt lgkmcnt(6)
    v_mfma_f32_32x32x16_bf16 v[80:95], a[4:7], v[228:231], v[80:95]
    ds_read_b64_tr_b16 a[20:21], v19 offset:64512
    ds_read_b64_tr_b16 a[22:23], v19 offset:64768
    v_cmp_gt_i32 s[80:81], 16, v68
    v_cmp_gt_i32 s[82:83], 17, v68
    v_cmp_gt_i32 s[84:85], 18, v68
    s_waitcnt lgkmcnt(6)
    v_mfma_f32_32x32x16_bf16 v[80:95], a[8:11], v[232:235], v[80:95]
    ds_read_b64_tr_b16 a[24:25], v20 offset:39936
    ds_read_b64_tr_b16 a[26:27], v20 offset:40192
    s_add_u32 m0, s7, 36864
    s_add_u32 s96, s61, 49152
    buffer_load_dwordx4 v1, s[20:23], s96 offen offset:0 lds
    buffer_load_dwordx4 v2, s[20:23], s96 offen offset:1024 lds
    s_waitcnt lgkmcnt(6)
    v_mfma_f32_32x32x16_bf16 v[80:95], a[12:15], v[236:239], v[80:95]
    ds_read_b64_tr_b16 a[28:29], v21 offset:15360
    ds_read_b64_tr_b16 a[30:31], v21 offset:15616
    v_cmp_gt_i32 s[86:87], 19, v68
    v_cmp_gt_i32 s[88:89], 24, v68
    v_cmp_gt_i32 s[90:91], 25, v68
    s_waitcnt lgkmcnt(6)
    v_mfma_f32_32x32x16_bf16 v[80:95], a[16:19], v[240:243], v[80:95]
    v_cmp_gt_i32 s[92:93], 26, v68
    v_cmp_gt_i32 s[94:95], 27, v68
    v_cndmask_b32 v104, 0, v69, s[64:65]
    v_cndmask_b32 v71, 0, v70, s[66:67]
    v_or_b32 v104, v104, v71
    s_waitcnt lgkmcnt(4)
    v_mfma_f32_32x32x16_bf16 v[80:95], a[20:23], v[244:247], v[80:95]
    v_cndmask_b32 v105, 0, v69, s[68:69]
    v_cndmask_b32 v71, 0, v70, s[70:71]
    v_or_b32_e64 v105, v105, v71
    v_cndmask_b32 v106, 0, v69, s[72:73]
    v_cndmask_b32 v71, 0, v70, s[74:75]
    s_waitcnt lgkmcnt(2)
    v_mfma_f32_32x32x16_bf16 v[80:95], a[24:27], v[248:251], v[80:95]
    s_waitcnt vmcnt(10)
    s_add_u32 s56, s58, 8192
    s_mov_b64 exec, 1
    buffer_store_dwordx2 v[6:7], off, s[28:31], s56 sc0 sc1
    s_mov_b64 exec, -1
    s_waitcnt lgkmcnt(0)
    v_mfma_f32_32x32x16_bf16 v[80:95], a[28:31], v[252:255], v[80:95]
    v_or_b32 v106, v106, v71
    v_cndmask_b32 v107, 0, v69, s[76:77]
    v_cndmask_b32 v71, 0, v70, s[78:79]
    v_or_b32_e64 v107, v107, v71
    v_cndmask_b32 v108, 0, v69, s[80:81]
    v_cndmask_b32 v71, 0, v70, s[82:83]
    v_or_b32_e64 v108, v108, v71
    v_cndmask_b32 v109, 0, v69, s[84:85]
    v_cndmask_b32 v71, 0, v70, s[86:87]
    v_or_b32_e64 v109, v109, v71
    v_cndmask_b32 v110, 0, v69, s[88:89]
    v_cndmask_b32 v71, 0, v70, s[90:91]
    v_or_b32_e64 v110, v110, v71
    v_cndmask_b32 v111, 0, v69, s[92:93]
    v_cndmask_b32 v71, 0, v70, s[94:95]
    v_or_b32_e64 v111, v111, v71
    s_lshl_b32 s59, s5, 13
    s_lshl_b32 s55, s3, 10
    s_add_u32 s59, s59, s55
    s_and_b32 s54, s5, 1
    s_mul_i32 s54, s54, 180224
    s_sub_u32 s54, 360448, s54
    s_mov_b32 s14, 176128
    s_mov_b32 s15, 0x20000
    v_add_u32 v12, 14336, v1
    v_add_u32 v22, 21504, v1
    s_sub_u32 s12, s40, s54
    s_subb_u32 s13, s41, 0
    v_mov_b32 v122, 0x3eb8aa3b
    s_waitcnt vmcnt(9)
    s_waitcnt lgkmcnt(0)
    s_barrier
    ds_read_b128 a[0:3], v60 offset:8448
    ds_read_b128 a[4:7], v60 offset:0
    ds_read_b128 a[8:11], v63 offset:4224
    ds_read_b128 a[12:15], v62 offset:4224
    v_mul_f32 v80, v122, v80
    v_mul_f32_e64 v81, v122, v81
    s_add_u32 m0, s7, 26624
    s_add_u32 s96, s61, 65536
    buffer_load_dwordx4 v1, s[20:23], s96 offen offset:0 lds
    buffer_load_dwordx4 v2, s[20:23], s96 offen offset:1024 lds
    v_mul_f32 v82, v122, v82
    v_mul_f32 v83, v122, v83
    v_mul_f32 v84, v122, v84
    v_mul_f32 v85, v122, v85
    v_mul_f32 v86, v122, v86
    v_mul_f32 v87, v122, v87
    v_cvt_pk_bf16_f32 v96, v80, v81
    v_cvt_pk_bf16_f32 v97, v82, v83
    v_cvt_pk_bf16_f32 v98, v84, v85
    v_cvt_pk_bf16_f32 v99, v86, v87
    s_waitcnt lgkmcnt(3)
    s_nop 0
    v_mfma_f32_32x32x16_bf16 v[128:143], a[0:3], v[96:99], 0
    ds_read_b128 a[16:19], v61 offset:4224
    s_waitcnt lgkmcnt(3)
    v_mfma_f32_32x32x16_bf16 v[144:159], a[4:7], v[96:99], 0
    ds_read_b128 a[20:23], v60 offset:4224
    ds_read_b128 a[72:75], v112 offset:10560
    ds_read_b128 a[76:79], v112 offset:11616
    v_mul_f32 v88, v122, v88
    v_mul_f32 v89, v122, v89
    v_mul_f32 v90, v122, v90
    v_mul_f32 v91, v122, v91
    v_mul_f32 v92, v122, v92
    s_add_u32 m0, s7, 28672
    s_add_u32 s96, s61, 81920
    buffer_load_dwordx4 v1, s[20:23], s96 offen offset:0 lds
    buffer_load_dwordx4 v2, s[20:23], s96 offen offset:1024 lds
    v_mul_f32 v93, v122, v93
    v_mul_f32 v94, v122, v94
    v_mul_f32_e64 v95, v122, v95
    v_cvt_pk_bf16_f32 v100, v88, v89
    v_cvt_pk_bf16_f32 v101, v90, v91
    v_cvt_pk_bf16_f32 v102, v92, v93
    v_cvt_pk_bf16_f32 v103, v94, v95
    s_waitcnt lgkmcnt(5)
    v_mfma_f32_32x32x16_bf16 v[160:175], a[8:11], v[96:99], 0
    ds_read_b128 a[0:3], v63 offset:0
    ds_read_b128 a[80:83], v112 offset:2112
    ds_read_b128 a[84:87], v112 offset:3168
    v_cndmask_b32 v144, v128, v144, s[64:65]
    v_cndmask_b32 v145, v129, v145, s[66:67]
    v_cndmask_b32 v146, v130, v146, s[68:69]
    v_cndmask_b32 v147, v131, v147, s[70:71]
    v_cndmask_b32 v148, v132, v148, s[72:73]
    v_cndmask_b32 v149, v133, v149, s[74:75]
    v_cndmask_b32 v150, v134, v150, s[76:77]
    v_cndmask_b32 v151, v135, v151, s[78:79]
    v_cndmask_b32 v152, v136, v152, s[80:81]
    v_cndmask_b32 v153, v137, v153, s[82:83]
    v_cndmask_b32 v154, v138, v154, s[84:85]
    v_cndmask_b32 v155, v139, v155, s[86:87]
    v_cndmask_b32 v156, v140, v156, s[88:89]
    v_cndmask_b32 v157, v141, v157, s[90:91]
    v_cndmask_b32 v158, v142, v158, s[92:93]
    v_cndmask_b32 v159, v143, v159, s[94:95]
    v_exp_f32 v144, v144
    s_add_u32 m0, s7, 14336
    s_add_u32 s96, s61, 98304
    buffer_load_dwordx4 v1, s[20:23], s96 offen offset:0 lds
    buffer_load_dwordx4 v2, s[20:23], s96 offen offset:1024 lds
    v_exp_f32 v145, v145
    v_exp_f32 v146, v146
    v_exp_f32_e64 v147, v147
    v_cvt_pk_bf16_f32 v32, v144, v145
    s_waitcnt lgkmcnt(7)
    v_mfma_f32_32x32x16_bf16 v[176:191], a[12:15], v[96:99], 0
    ds_read_b128 a[4:7], v62 offset:0
    ds_read_b128 a[88:91], v115 offset:6336
    ds_read_b128 a[92:95], v115 offset:7392
    v_exp_f32 v148, v148
    v_exp_f32_e64 v149, v149
    v_cvt_pk_bf16_f32 v33, v146, v147
    v_exp_f32 v150, v150
    v_exp_f32 v151, v151
    v_cvt_pk_bf16_f32 v34, v148, v149
    s_waitcnt lgkmcnt(9)
    v_mfma_f32_32x32x16_bf16 v[128:143], a[16:19], v[96:99], 0
    ds_read_b128 a[8:11], v61 offset:0
    ds_read_b128 a[96:99], v114 offset:6336
    ds_read_b128 a[100:103], v114 offset:7392
    buffer_load_dwordx4 v12, s[20:23], s96 offen offset:2048 lds
    buffer_load_dwordx4 v22, s[20:23], s96 offen offset:3072 lds
    v_exp_f32 v152, v152
    v_exp_f32_e64 v153, v153
    v_cvt_pk_bf16_f32 v35, v150, v151
    v_exp_f32 v154, v154
    v_exp_f32 v155, v155
    v_cvt_pk_bf16_f32 v36, v152, v153
    v_exp_f32 v156, v156
    v_exp_f32 v157, v157
    v_cvt_pk_bf16_f32 v37, v154, v155
    v_exp_f32 v158, v158
    v_exp_f32 v159, v159
    v_cvt_pk_bf16_f32 v38, v156, v157
    v_cvt_pk_bf16_f32 v39, v158, v159
    v_and_b32 v40, v32, v104
    v_and_b32 v41, v33, v105
    v_and_b32 v42, v34, v106
    v_and_b32 v43, v35, v107
    v_and_b32 v44, v36, v108
    v_and_b32 v45, v37, v109
    v_and_b32 v46, v38, v110
    v_and_b32 v47, v39, v111
    v_xor_b32 v32, v32, v40
    v_xor_b32 v33, v33, v41
    v_xor_b32 v34, v34, v42
    v_xor_b32 v35, v35, v43
    v_xor_b32 v36, v36, v44
    v_xor_b32 v37, v37, v45
    v_xor_b32 v38, v38, v46
    v_xor_b32 v39, v39, v47
    v_exp_f32 v160, v160
    v_exp_f32 v161, v161
    v_exp_f32 v162, v162
    v_exp_f32 v163, v163
    v_cvt_pk_bf16_f32 v48, v160, v161
    s_waitcnt lgkmcnt(10)
    v_mfma_f32_32x32x16_bf16 v[224:239], a[72:75], v[32:35], 0
    v_exp_f32 v164, v164
    v_exp_f32_e64 v165, v165
    v_cvt_pk_bf16_f32 v49, v162, v163
    v_exp_f32 v166, v166
    v_exp_f32 v167, v167
    v_cvt_pk_bf16_f32 v50, v164, v165
    s_waitcnt lgkmcnt(9)
    v_mfma_f32_32x32x16_bf16 v[224:239], a[76:79], v[36:39], v[224:239]
    v_exp_f32 v168, v168
    v_exp_f32_e64 v169, v169
    v_cvt_pk_bf16_f32 v51, v166, v167
    v_exp_f32 v170, v170
    v_exp_f32 v171, v171
    v_cvt_pk_bf16_f32 v52, v168, v169
    s_waitcnt lgkmcnt(7)
    v_mfma_f32_32x32x16_bf16 v[224:239], a[80:83], v[40:43], v[224:239]
    v_exp_f32 v172, v172
    v_exp_f32_e64 v173, v173
    v_cvt_pk_bf16_f32 v53, v170, v171
    s_waitcnt lgkmcnt(6)
    v_mfma_f32_32x32x16_bf16 v[224:239], a[84:87], v[44:47], v[224:239]
    ds_read_b128 a[72:75], v113 offset:6336
    ds_read_b128 a[76:79], v113 offset:7392
    v_exp_f32 v174, v174
    v_exp_f32_e64 v175, v175
    v_cvt_pk_bf16_f32 v54, v172, v173
    v_cvt_pk_bf16_f32 v55, v174, v175
    v_exp_f32 v176, v176
    v_exp_f32 v177, v177
    v_exp_f32 v178, v178
    v_exp_f32 v179, v179
    v_cvt_pk_bf16_f32 v32, v176, v177
    s_waitcnt lgkmcnt(6)
    v_mfma_f32_32x32x16_bf16 v[224:239], a[88:91], v[48:51], v[224:239]
    v_exp_f32 v180, v180
    v_exp_f32 v181, v181
    s_waitcnt vmcnt(13)
    ds_read_b64_tr_b16 a[104:105], v3 offset:30720
    ds_read_b64_tr_b16 a[106:107], v3 offset:31744
    ds_read_b64_tr_b16 a[108:109], v4 offset:30720
    ds_read_b64_tr_b16 a[110:111], v4 offset:31744
    v_cvt_pk_bf16_f32 v33, v178, v179
    ds_read_b64_tr_b16 a[112:113], v3 offset:32768
    ds_read_b64_tr_b16 a[114:115], v3 offset:33792
    ds_read_b64_tr_b16 a[116:117], v4 offset:32768
    ds_read_b64_tr_b16 a[118:119], v4 offset:33792
    v_exp_f32_e64 v182, v182
    s_add_u32 m0, s7, 18432
    s_add_u32 s96, s61, 131072
    buffer_load_dwordx4 v1, s[20:23], s96 offen offset:0 lds
    buffer_load_dwordx4 v2, s[20:23], s96 offen offset:1024 lds
    v_exp_f32_e64 v183, v183
    v_cvt_pk_bf16_f32 v34, v180, v181
    s_waitcnt lgkmcnt(13)
    v_mfma_f32_32x32x16_bf16 v[224:239], a[92:95], v[52:55], v[224:239]
    ds_read_b128 a[80:83], v112 offset:6336
    ds_read_b128 a[84:87], v112 offset:7392
    v_exp_f32 v184, v184
    v_exp_f32_e64 v185, v185
    v_cvt_pk_bf16_f32 v35, v182, v183
    v_exp_f32 v186, v186
    v_exp_f32 v187, v187
    buffer_load_dwordx4 v12, s[20:23], s96 offen offset:2048 lds
    buffer_load_dwordx4 v22, s[20:23], s96 offen offset:3072 lds
    v_cvt_pk_bf16_f32 v36, v184, v185
    v_mfma_f32_32x32x16_bf16 v[144:159], a[20:23], v[96:99], 0
    ds_read_b128 a[12:15], v60 offset:9504
    v_exp_f32 v188, v188
    v_exp_f32 v189, v189
    v_cvt_pk_bf16_f32 v37, v186, v187
    v_exp_f32 v190, v190
    v_exp_f32 v191, v191
    v_cvt_pk_bf16_f32 v38, v188, v189
    v_cvt_pk_bf16_f32 v39, v190, v191
    v_exp_f32 v128, v128
    v_exp_f32 v129, v129
    v_exp_f32 v130, v130
    v_exp_f32_e64 v131, v131
    s_waitcnt vmcnt(13)
    ds_read_b64_tr_b16 a[120:121], v3 offset:34816
    ds_read_b64_tr_b16 a[122:123], v3 offset:35840
    ds_read_b64_tr_b16 a[124:125], v4 offset:34816
    ds_read_b64_tr_b16 a[126:127], v4 offset:35840
    v_cvt_pk_bf16_f32 v40, v128, v129
    s_waitcnt lgkmcnt(15)
    v_mfma_f32_32x32x16_bf16 v[224:239], a[96:99], v[32:35], v[224:239]
    ds_read_b64_tr_b16 a[128:129], v3 offset:36864
    ds_read_b64_tr_b16 a[130:131], v3 offset:37888
    ds_read_b64_tr_b16 a[132:133], v4 offset:36864
    ds_read_b64_tr_b16 a[134:135], v4 offset:37888
    v_exp_f32 v132, v132
    s_add_u32 m0, s7, 22528
    s_add_u32 s96, s61, 163840
    buffer_load_dwordx4 v1, s[20:23], s96 offen offset:0 lds
    buffer_load_dwordx4 v2, s[20:23], s96 offen offset:1024 lds
    v_exp_f32_e64 v133, v133
    v_cvt_pk_bf16_f32 v41, v130, v131
    v_exp_f32 v134, v134
    v_exp_f32 v135, v135
    v_cvt_pk_bf16_f32 v42, v132, v133
    s_waitcnt lgkmcnt(15)
    v_mfma_f32_32x32x16_bf16 v[224:239], a[100:103], v[36:39], v[224:239]
    ds_read_b128 a[88:91], v115 offset:2112
    ds_read_b128 a[92:95], v115 offset:3168
    v_exp_f32 v136, v136
    v_exp_f32_e64 v137, v137
    buffer_load_dwordx4 v12, s[20:23], s96 offen offset:2048 lds
    buffer_load_dwordx4 v22, s[20:23], s96 offen offset:3072 lds
    v_cvt_pk_bf16_f32 v43, v134, v135
    v_exp_f32 v138, v138
    v_exp_f32 v139, v139
    v_cvt_pk_bf16_f32 v44, v136, v137
    v_mfma_f32_32x32x16_bf16 v[160:175], a[0:3], v[96:99], 0
    ds_read_b128 a[16:19], v60 offset:1056
    v_exp_f32 v140, v140
    v_exp_f32 v141, v141
    v_cvt_pk_bf16_f32 v45, v138, v139
    v_exp_f32 v142, v142
    v_exp_f32 v143, v143
    v_cvt_pk_bf16_f32 v46, v140, v141
    v_cvt_pk_bf16_f32 v47, v142, v143
    v_exp_f32 v144, v144
    v_exp_f32 v145, v145
    v_exp_f32 v146, v146
    v_exp_f32_e64 v147, v147
    s_waitcnt vmcnt(12)
    ds_read_b64_tr_b16 a[136:137], v3 offset:26624
    ds_read_b64_tr_b16 a[138:139], v3 offset:27648
    ds_read_b64_tr_b16 a[140:141], v4 offset:26624
    ds_read_b64_tr_b16 a[142:143], v4 offset:27648
    v_cvt_pk_bf16_f32 v48, v144, v145
    s_waitcnt lgkmcnt(15)
    v_mfma_f32_32x32x16_bf16 v[224:239], a[72:75], v[40:43], v[224:239]
    ds_read_b64_tr_b16 a[144:145], v3 offset:28672
    ds_read_b64_tr_b16 a[146:147], v3 offset:29696
    ds_read_b64_tr_b16 a[148:149], v4 offset:28672
    ds_read_b64_tr_b16 a[150:151], v4 offset:29696
    v_exp_f32_e64 v148, v148
    s_waitcnt lgkmcnt(15)
    s_add_u32 m0, s7, 30720
    s_add_u32 s96, s61, 196608
    buffer_load_dwordx4 v1, s[20:23], s96 offen offset:0 lds
    buffer_load_dwordx4 v2, s[20:23], s96 offen offset:1024 lds
    v_exp_f32_e64 v149, v149
    v_cvt_pk_bf16_f32 v49, v146, v147
    v_exp_f32 v150, v150
    v_exp_f32 v151, v151
    v_cvt_pk_bf16_f32 v50, v148, v149
    v_mfma_f32_32x32x16_bf16 v[224:239], a[76:79], v[44:47], v[224:239]
    ds_read_b128 a[96:99], v114 offset:2112
    ds_read_b128 a[100:103], v114 offset:3168
    v_exp_f32 v152, v152
    v_exp_f32 v153, v153
    buffer_load_dwordx4 v12, s[20:23], s96 offen offset:2048 lds
    buffer_load_dwordx4 v22, s[20:23], s96 offen offset:3072 lds
    v_cvt_pk_bf16_f32 v51, v150, v151
    v_exp_f32 v154, v154
    v_exp_f32 v155, v155
    v_cvt_pk_bf16_f32 v52, v152, v153
    v_mfma_f32_32x32x16_bf16 v[176:191], a[4:7], v[96:99], 0
    ds_read_b128 a[20:23], v63 offset:5280
    v_exp_f32 v156, v156
    v_exp_f32 v157, v157
    v_cvt_pk_bf16_f32 v53, v154, v155
    v_exp_f32 v158, v158
    v_exp_f32 v159, v159
    v_cvt_pk_bf16_f32 v54, v156, v157
    v_cvt_pk_bf16_f32 v55, v158, v159
    v_exp_f32 v160, v160
    v_exp_f32_e64 v161, v161
    s_waitcnt vmcnt(12)
    ds_read_b64_tr_b16 a[152:153], v3 offset:14336
    ds_read_b64_tr_b16 a[154:155], v3 offset:15360
    ds_read_b64_tr_b16 a[156:157], v4 offset:14336
    ds_read_b64_tr_b16 a[158:159], v4 offset:15360
    v_exp_f32_e64 v162, v162
    ds_read_b64_tr_b16 a[160:161], v3 offset:16384
    ds_read_b64_tr_b16 a[162:163], v3 offset:17408
    ds_read_b64_tr_b16 a[164:165], v4 offset:16384
    ds_read_b64_tr_b16 a[166:167], v4 offset:17408
    v_exp_f32 v163, v163
    s_waitcnt lgkmcnt(15)
    s_add_u32 m0, s7, 34816
    s_add_u32 s96, s61, 229376
    buffer_load_dwordx4 v1, s[20:23], s96 offen offset:0 lds
    buffer_load_dwordx4 v2, s[20:23], s96 offen offset:1024 lds
    v_cvt_pk_bf16_f32 v32, v160, v161
    v_mfma_f32_32x32x16_bf16 v[224:239], a[80:83], v[48:51], v[224:239]
    v_exp_f32 v164, v164
    v_exp_f32 v165, v165
    v_cvt_pk_bf16_f32 v33, v162, v163
    v_exp_f32 v166, v166
    v_exp_f32 v167, v167
    v_cvt_pk_bf16_f32 v34, v164, v165
    v_mfma_f32_32x32x16_bf16 v[224:239], a[84:87], v[52:55], v[224:239]
    ds_read_b128 a[72:75], v113 offset:2112
    ds_read_b128 a[76:79], v113 offset:3168
    buffer_load_dwordx4 v12, s[20:23], s96 offen offset:2048 lds
    buffer_load_dwordx4 v22, s[20:23], s96 offen offset:3072 lds
    v_exp_f32 v168, v168
    v_exp_f32 v169, v169
    v_cvt_pk_bf16_f32 v35, v166, v167
    v_exp_f32 v170, v170
    v_exp_f32 v171, v171
    v_cvt_pk_bf16_f32 v36, v168, v169
    v_mfma_f32_32x32x16_bf16 v[128:143], a[8:11], v[96:99], 0
    ds_read_b128 a[0:3], v62 offset:5280
    buffer_load_dwordx2 v[8:9], v13, s[28:31], 0 offen sc1
    v_exp_f32 v172, v172
    v_exp_f32 v173, v173
    v_cvt_pk_bf16_f32 v37, v170, v171
    v_exp_f32 v174, v174
    v_exp_f32 v175, v175
    v_cvt_pk_bf16_f32 v38, v172, v173
    v_cvt_pk_bf16_f32 v39, v174, v175
    v_exp_f32 v176, v176
    v_exp_f32 v177, v177
    v_exp_f32 v178, v178
    s_waitcnt vmcnt(13)
    ds_read_b64_tr_b16 a[168:169], v3 offset:18432
    ds_read_b64_tr_b16 a[170:171], v3 offset:19456
    ds_read_b64_tr_b16 a[172:173], v4 offset:18432
    ds_read_b64_tr_b16 a[174:175], v4 offset:19456
    v_exp_f32_e64 v179, v179
    ds_read_b64_tr_b16 a[176:177], v3 offset:20480
    ds_read_b64_tr_b16 a[178:179], v3 offset:21504
    ds_read_b64_tr_b16 a[180:181], v4 offset:20480
    ds_read_b64_tr_b16 a[182:183], v4 offset:21504
    v_cvt_pk_bf16_f32 v40, v176, v177
    s_waitcnt lgkmcnt(15)
    v_mfma_f32_32x32x16_bf16 v[224:239], a[88:91], v[32:35], v[224:239]
    s_waitcnt lgkmcnt(15)
    s_add_u32 m0, s7, 26624
    s_add_u32 s96, s61, 262144
    buffer_load_dwordx4 v1, s[20:23], s96 offen offset:0 lds
    buffer_load_dwordx4 v2, s[20:23], s96 offen offset:1024 lds
    v_exp_f32 v180, v180
    v_exp_f32 v181, v181
    v_cvt_pk_bf16_f32 v41, v178, v179
    v_exp_f32 v182, v182
    v_exp_f32 v183, v183
    v_cvt_pk_bf16_f32 v42, v180, v181
    v_mfma_f32_32x32x16_bf16 v[224:239], a[92:95], v[36:39], v[224:239]
    ds_read_b128 a[80:83], v116 offset:10560
    ds_read_b128 a[84:87], v116 offset:11616
    v_exp_f32_e64 v184, v184
    buffer_load_dwordx4 v12, s[20:23], s96 offen offset:2048 lds
    buffer_load_dwordx4 v22, s[20:23], s96 offen offset:3072 lds
    v_exp_f32_e64 v185, v185
    v_cvt_pk_bf16_f32 v43, v182, v183
    v_exp_f32 v186, v186
    v_exp_f32 v187, v187
    v_cvt_pk_bf16_f32 v44, v184, v185
    v_mfma_f32_32x32x16_bf16 v[144:159], a[12:15], v[100:103], 0
    ds_read_b128 a[4:7], v61 offset:5280
    v_exp_f32 v188, v188
    v_exp_f32 v189, v189
    v_cvt_pk_bf16_f32 v45, v186, v187
    v_exp_f32 v190, v190
    v_exp_f32 v191, v191
    v_cvt_pk_bf16_f32 v46, v188, v189
    v_cvt_pk_bf16_f32 v47, v190, v191
    s_waitcnt lgkmcnt(14)
    s_add_u32 m0, s7, 14336
    s_add_u32 s96, s61, 294912
    buffer_load_dwordx4 v1, s[20:23], s96 offen offset:0 lds
    buffer_load_dwordx4 v2, s[20:23], s96 offen offset:1024 lds
    v_exp_f32 v128, v128
    v_exp_f32 v129, v129
    v_exp_f32 v130, v130
    v_exp_f32_e64 v131, v131
    v_cvt_pk_bf16_f32 v48, v128, v129
    v_mfma_f32_32x32x16_bf16 v[224:239], a[96:99], v[40:43], v[224:239]
    v_exp_f32 v132, v132
    v_exp_f32 v133, v133
    v_cvt_pk_bf16_f32 v49, v130, v131
    v_exp_f32 v134, v134
    v_exp_f32 v135, v135
    v_cvt_pk_bf16_f32 v50, v132, v133
    v_mfma_f32_32x32x16_bf16 v[224:239], a[100:103], v[44:47], v[224:239]
    ds_read_b128 a[88:91], v116 offset:2112
    ds_read_b128 a[92:95], v116 offset:3168
    buffer_load_dwordx4 v12, s[20:23], s96 offen offset:2048 lds
    buffer_load_dwordx4 v22, s[20:23], s96 offen offset:3072 lds
    v_exp_f32 v136, v136
    v_exp_f32 v137, v137
    v_cvt_pk_bf16_f32 v51, v134, v135
    v_exp_f32 v138, v138
    v_exp_f32 v139, v139
    v_cvt_pk_bf16_f32 v52, v136, v137
    v_mfma_f32_32x32x16_bf16 v[160:175], a[16:19], v[100:103], 0
    ds_read_b128 a[8:11], v60 offset:5280
    v_exp_f32 v140, v140
    v_exp_f32 v141, v141
    v_cvt_pk_bf16_f32 v53, v138, v139
    v_exp_f32 v142, v142
    v_exp_f32 v143, v143
    v_cvt_pk_bf16_f32 v54, v140, v141
    v_cvt_pk_bf16_f32 v55, v142, v143
    s_nop 3
    v_cndmask_b32 v160, v144, v160, s[64:65]
    s_waitcnt lgkmcnt(6)
    s_add_u32 m0, s7, 18432
    s_add_u32 s96, s61, 327680
    buffer_load_dwordx4 v1, s[20:23], s96 offen offset:0 lds
    buffer_load_dwordx4 v2, s[20:23], s96 offen offset:1024 lds
    v_cndmask_b32 v161, v145, v161, s[66:67]
    v_cndmask_b32 v162, v146, v162, s[68:69]
    v_cndmask_b32 v163, v147, v163, s[70:71]
    v_cndmask_b32 v164, v148, v164, s[72:73]
    v_cndmask_b32 v165, v149, v165, s[74:75]
    v_cndmask_b32 v166, v150, v166, s[76:77]
    v_cndmask_b32 v167, v151, v167, s[78:79]
    v_cndmask_b32 v168, v152, v168, s[80:81]
    v_cndmask_b32 v169, v153, v169, s[82:83]
    v_cndmask_b32 v170, v154, v170, s[84:85]
    v_cndmask_b32 v171, v155, v171, s[86:87]
    v_cndmask_b32 v172, v156, v172, s[88:89]
    v_cndmask_b32 v173, v157, v173, s[90:91]
    v_cndmask_b32 v174, v158, v174, s[92:93]
    v_cndmask_b32 v175, v159, v175, s[94:95]
    v_exp_f32 v160, v160
    v_exp_f32 v161, v161
    v_mfma_f32_32x32x16_bf16 v[224:239], a[72:75], v[48:51], v[224:239]
    v_exp_f32 v162, v162
    v_exp_f32 v163, v163
    buffer_load_dwordx4 v12, s[20:23], s96 offen offset:2048 lds
    buffer_load_dwordx4 v22, s[20:23], s96 offen offset:3072 lds
    v_cvt_pk_bf16_f32 v32, v160, v161
    v_mfma_f32_32x32x16_bf16 v[224:239], a[76:79], v[52:55], v[224:239]
    ds_read_b128 a[96:99], v119 offset:6336
    ds_read_b128 a[100:103], v119 offset:7392
    v_exp_f32 v164, v164
    v_exp_f32 v165, v165
    v_cvt_pk_bf16_f32 v33, v162, v163
    v_mfma_f32_32x32x16_bf16 v[176:191], a[20:23], v[100:103], 0
    ds_read_b128 a[12:15], v63 offset:1056
    ds_read_b128 a[72:75], v118 offset:6336
    ds_read_b128 a[76:79], v118 offset:7392
    v_exp_f32 v166, v166
    v_exp_f32 v167, v167
    v_cvt_pk_bf16_f32 v34, v164, v165
    v_mfma_f32_32x32x16_bf16 v[128:143], a[0:3], v[100:103], 0
    ds_read_b128 a[16:19], v62 offset:1056
    s_waitcnt vmcnt(12)
    v_cmp_ne_u64 vcc, s[52:53], v[8:9]
    s_nop 0
    s_cmp_eq_u64 vcc, 0
    s_cbranch_scc0 Lpoll_5
Lpollb_6:
    v_exp_f32 v168, v168
    s_add_u32 s1, s8, 20480
    buffer_load_dwordx4 a[24:27], v25, s[12:15], s1 offen offset:0 sc1
    buffer_load_dwordx4 a[28:31], v26, s[12:15], s1 offen offset:0 sc1
    v_exp_f32_e64 v169, v169
    v_cvt_pk_bf16_f32 v35, v166, v167
    s_waitcnt lgkmcnt(9)
    v_mfma_f32_32x32x16_bf16 v[144:159], a[4:7], v[100:103], 0
    ds_read_b128 a[20:23], v61 offset:1056
    v_exp_f32 v170, v170
    v_exp_f32_e64 v171, v171
    v_cvt_pk_bf16_f32 v36, v168, v169
    v_exp_f32 v172, v172
    v_exp_f32 v173, v173
    v_cvt_pk_bf16_f32 v37, v170, v171
    v_exp_f32_e64 v174, v174
    buffer_load_dwordx4 a[32:35], v25, s[12:15], s1 offen offset:2048 sc1
    buffer_load_dwordx4 a[36:39], v26, s[12:15], s1 offen offset:2048 sc1
    v_exp_f32_e64 v175, v175
    v_cvt_pk_bf16_f32 v38, v172, v173
    v_cvt_pk_bf16_f32 v39, v174, v175
    v_and_b32 v40, v32, v104
    v_and_b32 v41, v33, v105
    v_and_b32 v42, v34, v106
    v_and_b32 v43, v35, v107
    v_and_b32 v44, v36, v108
    v_and_b32 v45, v37, v109
    v_and_b32 v46, v38, v110
    v_and_b32 v47, v39, v111
    v_xor_b32 v32, v32, v40
    v_xor_b32 v33, v33, v41
    v_xor_b32 v34, v34, v42
    v_xor_b32 v35, v35, v43
    v_xor_b32 v36, v36, v44
    v_xor_b32 v37, v37, v45
    v_xor_b32 v38, v38, v46
    v_xor_b32 v39, v39, v47
    v_exp_f32 v176, v176
    v_exp_f32 v177, v177
    s_add_u32 s1, s8, 24576
    buffer_load_dwordx4 a[40:43], v25, s[12:15], s1 offen offset:0 sc1
    buffer_load_dwordx4 a[44:47], v26, s[12:15], s1 offen offset:0 sc1
    v_exp_f32 v178, v178
    v_exp_f32 v179, v179
    v_cvt_pk_bf16_f32 v48, v176, v177
    v_mfma_f32_32x32x16_bf16 v[240:255], a[80:83], v[32:35], 0
    v_exp_f32 v180, v180
    v_exp_f32 v181, v181
    v_cvt_pk_bf16_f32 v49, v178, v179
    v_exp_f32 v182, v182
    v_exp_f32 v183, v183
    v_cvt_pk_bf16_f32 v50, v180, v181
    v_mfma_f32_32x32x16_bf16 v[240:255], a[84:87], v[36:39], v[240:255]
    v_exp_f32 v184, v184
    v_exp_f32 v185, v185
    v_cvt_pk_bf16_f32 v51, v182, v183
    v_exp_f32 v186, v186
    v_exp_f32 v187, v187
    buffer_load_dwordx4 a[48:51], v25, s[12:15], s1 offen offset:2048 sc1
    buffer_load_dwordx4 a[52:55], v26, s[12:15], s1 offen offset:2048 sc1
    v_cvt_pk_bf16_f32 v52, v184, v185
    s_waitcnt lgkmcnt(9)
    v_mfma_f32_32x32x16_bf16 v[240:255], a[88:91], v[40:43], v[240:255]
    v_exp_f32 v188, v188
    v_exp_f32_e64 v189, v189
    v_cvt_pk_bf16_f32 v53, v186, v187
    s_waitcnt lgkmcnt(8)
    v_mfma_f32_32x32x16_bf16 v[240:255], a[92:95], v[44:47], v[240:255]
    ds_read_b128 a[80:83], v117 offset:6336
    ds_read_b128 a[84:87], v117 offset:7392
    v_exp_f32 v190, v190
    v_exp_f32_e64 v191, v191
    v_cvt_pk_bf16_f32 v54, v188, v189
    v_cvt_pk_bf16_f32 v55, v190, v191
    v_rcp_f32 v72, v232
    s_add_u32 s54, s59, 0
    v_maximum3_f32 v73, |v224|, |v225|, |v226|
    v_maximum3_f32 v73, v73, |v227|, |v228|
    v_maximum3_f32 v73, v73, |v229|, |v230|
    v_maximum3_f32 v73, v73, |v231|, |v231|
    v_mul_f32 v73, 0x21800000, v73
    s_add_u32 s1, s8, 28672
    buffer_load_dwordx4 a[56:59], v25, s[12:15], s1 offen offset:0 sc1
    buffer_load_dwordx4 a[60:63], v26, s[12:15], s1 offen offset:0 sc1
    v_maximum3_f32 v73, v73, v232, v72
    v_mov_b32 v74, 0x4e800000
    v_cmp_nle_f32 s[16:17], v73, v74
    v_mul_f32 v224, v224, v72
    v_mul_f32 v225, v225, v72
    v_mul_f32 v226, v226, v72
    v_mul_f32 v227, v227, v72
    v_mul_f32 v228, v228, v72
    v_mul_f32 v229, v229, v72
    v_mul_f32 v230, v230, v72
    v_mul_f32 v231, v231, v72
    v_cvt_pk_bf16_f32 v76, v224, v225
    v_cvt_pk_bf16_f32 v77, v226, v227
    v_cvt_pk_bf16_f32 v78, v228, v229
    v_cvt_pk_bf16_f32 v79, v230, v231
    buffer_store_dwordx4 v[76:79], v24, s[40:43], s54 offen sc1
    v_exp_f32 v128, v128
    v_exp_f32 v129, v129
    v_exp_f32 v130, v130
    v_exp_f32 v131, v131
    v_cvt_pk_bf16_f32 v32, v128, v129
    s_waitcnt lgkmcnt(8)
    v_mfma_f32_32x32x16_bf16 v[240:255], a[96:99], v[48:51], v[240:255]
    v_exp_f32 v132, v132
    v_exp_f32_e64 v133, v133
    v_cvt_pk_bf16_f32 v33, v130, v131
    v_exp_f32 v134, v134
    v_exp_f32 v135, v135
    v_cvt_pk_bf16_f32 v34, v132, v133
    s_waitcnt lgkmcnt(7)
    v_mfma_f32_32x32x16_bf16 v[240:255], a[100:103], v[52:55], v[240:255]
    ds_read_b128 a[88:91], v116 offset:6336
    ds_read_b128 a[92:95], v116 offset:7392
    v_exp_f32 v136, v136
    buffer_load_dwordx4 a[64:67], v25, s[12:15], s1 offen offset:2048 sc1
    buffer_load_dwordx4 a[68:71], v26, s[12:15], s1 offen offset:2048 sc1
    v_exp_f32_e64 v137, v137
    v_cvt_pk_bf16_f32 v35, v134, v135
    v_exp_f32 v138, v138
    v_exp_f32 v139, v139
    v_cvt_pk_bf16_f32 v36, v136, v137
    v_mfma_f32_32x32x16_bf16 v[160:175], a[8:11], v[100:103], 0
    v_exp_f32 v140, v140
    v_exp_f32 v141, v141
    v_cvt_pk_bf16_f32 v37, v138, v139
    v_exp_f32 v142, v142
    v_exp_f32 v143, v143
    v_cvt_pk_bf16_f32 v38, v140, v141
    v_cvt_pk_bf16_f32 v39, v142, v143
    v_exp_f32 v144, v144
    v_exp_f32 v145, v145
    v_exp_f32_e64 v146, v146
    s_add_u32 s1, s8, 32768
    buffer_load_dwordx4 v[80:83], v25, s[12:15], s1 offen offset:0 sc1
    buffer_load_dwordx4 v[84:87], v26, s[12:15], s1 offen offset:0 sc1
    v_exp_f32_e64 v147, v147
    v_cvt_pk_bf16_f32 v40, v144, v145
    s_waitcnt lgkmcnt(7)
    v_mfma_f32_32x32x16_bf16 v[240:255], a[72:75], v[32:35], v[240:255]
    v_exp_f32 v148, v148
    v_exp_f32_e64 v149, v149
    v_cvt_pk_bf16_f32 v41, v146, v147
    v_exp_f32 v150, v150
    v_exp_f32 v151, v151
    v_cvt_pk_bf16_f32 v42, v148, v149
    s_waitcnt lgkmcnt(6)
    v_mfma_f32_32x32x16_bf16 v[240:255], a[76:79], v[36:39], v[240:255]
    ds_read_b128 a[96:99], v119 offset:2112
    ds_read_b128 a[100:103], v119 offset:3168
    v_exp_f32 v152, v152
    v_exp_f32_e64 v153, v153
    v_cvt_pk_bf16_f32 v43, v150, v151
    v_exp_f32 v154, v154
    v_exp_f32 v155, v155
    v_cvt_pk_bf16_f32 v44, v152, v153
    v_mfma_f32_32x32x16_bf16 v[176:191], a[12:15], v[100:103], 0
    buffer_load_dwordx4 v[88:91], v25, s[12:15], s1 offen offset:2048 sc1
    buffer_load_dwordx4 v[92:95], v26, s[12:15], s1 offen offset:2048 sc1
    v_exp_f32 v156, v156
    v_exp_f32 v157, v157
    v_cvt_pk_bf16_f32 v45, v154, v155
    v_exp_f32 v158, v158
    v_exp_f32 v159, v159
    v_cvt_pk_bf16_f32 v46, v156, v157
    v_cvt_pk_bf16_f32 v47, v158, v159
    v_exp_f32 v160, v160
    v_exp_f32 v161, v161
    v_exp_f32 v162, v162
    v_exp_f32 v163, v163
    v_cvt_pk_bf16_f32 v48, v160, v161
    s_waitcnt lgkmcnt(5)
    v_mfma_f32_32x32x16_bf16 v[240:255], a[80:83], v[40:43], v[240:255]
    v_exp_f32 v164, v164
    v_exp_f32_e64 v165, v165
    v_cvt_pk_bf16_f32 v49, v162, v163
    v_exp_f32 v166, v166
    v_exp_f32 v167, v167
    v_cvt_pk_bf16_f32 v50, v164, v165
    s_waitcnt lgkmcnt(4)
    v_mfma_f32_32x32x16_bf16 v[240:255], a[84:87], v[44:47], v[240:255]
    ds_read_b128 a[72:75], v118 offset:2112
    ds_read_b128 a[76:79], v118 offset:3168
    v_exp_f32 v168, v168
    v_exp_f32_e64 v169, v169
    v_cvt_pk_bf16_f32 v51, v166, v167
    v_exp_f32 v170, v170
    v_exp_f32 v171, v171
    v_cvt_pk_bf16_f32 v52, v168, v169
    v_mfma_f32_32x32x16_bf16 v[128:143], a[16:19], v[100:103], 0
    v_exp_f32 v172, v172
    v_exp_f32 v173, v173
    v_cvt_pk_bf16_f32 v53, v170, v171
    v_exp_f32 v174, v174
    v_exp_f32 v175, v175
    v_cvt_pk_bf16_f32 v54, v172, v173
    v_cvt_pk_bf16_f32 v55, v174, v175
    v_exp_f32 v176, v176
    v_exp_f32 v177, v177
    v_exp_f32 v178, v178
    v_exp_f32 v179, v179
    v_cvt_pk_bf16_f32 v32, v176, v177
    s_waitcnt lgkmcnt(5)
    v_mfma_f32_32x32x16_bf16 v[240:255], a[88:91], v[48:51], v[240:255]
    v_exp_f32 v180, v180
    v_exp_f32_e64 v181, v181
    s_add_u32 s1, s8, 36864
    buffer_load_dwordx4 v[192:195], v25, s[12:15], s1 offen offset:0 sc1
    buffer_load_dwordx4 v[196:199], v26, s[12:15], s1 offen offset:0 sc1
    v_cvt_pk_bf16_f32 v33, v178, v179
    v_exp_f32 v182, v182
    v_exp_f32 v183, v183
    v_cvt_pk_bf16_f32 v34, v180, v181
    s_waitcnt lgkmcnt(4)
    v_mfma_f32_32x32x16_bf16 v[240:255], a[92:95], v[52:55], v[240:255]
    ds_read_b128 a[80:83], v117 offset:2112
    ds_read_b128 a[84:87], v117 offset:3168
    v_exp_f32 v184, v184
    v_exp_f32_e64 v185, v185
    v_cvt_pk_bf16_f32 v35, v182, v183
    v_exp_f32 v186, v186
    v_exp_f32 v187, v187
    v_cvt_pk_bf16_f32 v36, v184, v185
    v_mfma_f32_32x32x16_bf16 v[144:159], a[20:23], v[100:103], 0
    v_exp_f32 v188, v188
    v_exp_f32 v189, v189
    v_cvt_pk_bf16_f32 v37, v186, v187
    v_exp_f32_e64 v190, v190
    buffer_load_dwordx4 v[200:203], v25, s[12:15], s1 offen offset:2048 sc1
    buffer_load_dwordx4 v[204:207], v26, s[12:15], s1 offen offset:2048 sc1
    v_exp_f32_e64 v191, v191
    v_cvt_pk_bf16_f32 v38, v188, v189
    v_cvt_pk_bf16_f32 v39, v190, v191
    v_exp_f32 v128, v128
    v_exp_f32 v129, v129
    v_exp_f32 v130, v130
    v_exp_f32 v131, v131
    v_cvt_pk_bf16_f32 v40, v128, v129
    s_waitcnt lgkmcnt(5)
    v_mfma_f32_32x32x16_bf16 v[240:255], a[96:99], v[32:35], v[240:255]
    v_exp_f32 v132, v132
    v_exp_f32_e64 v133, v133
    v_cvt_pk_bf16_f32 v41, v130, v131
    v_exp_f32 v134, v134
    v_exp_f32 v135, v135
    v_cvt_pk_bf16_f32 v42, v132, v133
    s_waitcnt lgkmcnt(4)
    v_mfma_f32_32x32x16_bf16 v[240:255], a[100:103], v[36:39], v[240:255]
    s_add_u32 s1, s8, 40960
    buffer_load_dwordx4 v[208:211], v25, s[12:15], s1 offen offset:0 sc1
    buffer_load_dwordx4 v[212:215], v26, s[12:15], s1 offen offset:0 sc1
    v_exp_f32 v136, v136
    v_exp_f32_e64 v137, v137
    v_cvt_pk_bf16_f32 v43, v134, v135
    v_exp_f32 v138, v138
    v_exp_f32 v139, v139
    v_cvt_pk_bf16_f32 v44, v136, v137
    v_exp_f32 v140, v140
    v_exp_f32 v141, v141
    v_cvt_pk_bf16_f32 v45, v138, v139
    v_exp_f32 v142, v142
    v_exp_f32 v143, v143
    v_cvt_pk_bf16_f32 v46, v140, v141
    v_cvt_pk_bf16_f32 v47, v142, v143
    v_exp_f32 v144, v144
    v_exp_f32 v145, v145
    v_exp_f32 v146, v146
    v_exp_f32 v147, v147
    buffer_load_dwordx4 v[216:219], v25, s[12:15], s1 offen offset:2048 sc1
    buffer_load_dwordx4 v[220:223], v26, s[12:15], s1 offen offset:2048 sc1
    v_cvt_pk_bf16_f32 v48, v144, v145
    s_waitcnt lgkmcnt(3)
    v_mfma_f32_32x32x16_bf16 v[240:255], a[72:75], v[40:43], v[240:255]
    v_exp_f32 v148, v148
    v_exp_f32_e64 v149, v149
    v_cvt_pk_bf16_f32 v49, v146, v147
    v_exp_f32 v150, v150
    v_exp_f32 v151, v151
    v_cvt_pk_bf16_f32 v50, v148, v149
    s_waitcnt lgkmcnt(2)
    v_mfma_f32_32x32x16_bf16 v[240:255], a[76:79], v[44:47], v[240:255]
    v_exp_f32 v152, v152
    v_exp_f32_e64 v153, v153
    v_cvt_pk_bf16_f32 v51, v150, v151
    v_exp_f32 v154, v154
    v_exp_f32 v155, v155
    v_cvt_pk_bf16_f32 v52, v152, v153
    v_exp_f32 v156, v156
    s_add_u32 s1, s8, 0
    buffer_load_dwordx4 a[184:187], v25, s[12:15], s1 offen offset:0 sc1
    buffer_load_dwordx4 a[188:191], v26, s[12:15], s1 offen offset:0 sc1
    v_exp_f32_e64 v157, v157
    v_cvt_pk_bf16_f32 v53, v154, v155
    v_exp_f32 v158, v158
    v_exp_f32 v159, v159
    v_cvt_pk_bf16_f32 v54, v156, v157
    v_cvt_pk_bf16_f32 v55, v158, v159
    s_waitcnt lgkmcnt(1)
    v_mfma_f32_32x32x16_bf16 v[240:255], a[80:83], v[48:51], v[240:255]
    s_waitcnt lgkmcnt(0)
    v_mfma_f32_32x32x16_bf16 v[240:255], a[84:87], v[52:55], v[240:255]
    s_nop 11
    v_rcp_f32 v72, v248
    s_add_u32 s54, s59, 4096
    v_maximum3_f32 v73, |v240|, |v241|, |v242|
    v_maximum3_f32 v73, v73, |v243|, |v244|
    v_maximum3_f32 v73, v73, |v245|, |v246|
    v_maximum3_f32 v73, v73, |v247|, |v247|
    v_mul_f32 v73, 0x21800000, v73
    v_maximum3_f32 v73, v73, v248, v72
    v_mov_b32 v74, 0x4e800000
    buffer_load_dwordx4 a[192:195], v25, s[12:15], s1 offen offset:2048 sc1
    buffer_load_dwordx4 a[196:199], v26, s[12:15], s1 offen offset:2048 sc1
    v_cmp_nle_f32 s[18:19], v73, v74
    v_mul_f32 v240, v240, v72
    v_mul_f32 v241, v241, v72
    v_mul_f32 v242, v242, v72
    v_mul_f32 v243, v243, v72
    v_mul_f32 v244, v244, v72
    v_mul_f32 v245, v245, v72
    v_mul_f32 v246, v246, v72
    v_mul_f32 v247, v247, v72
    v_cvt_pk_bf16_f32 v76, v240, v241
    v_cvt_pk_bf16_f32 v77, v242, v243
    v_cvt_pk_bf16_f32 v78, v244, v245
    v_cvt_pk_bf16_f32 v79, v246, v247
    buffer_store_dwordx4 v[76:79], v24, s[40:43], s54 offen sc1
    s_or_b64 s[16:17], s[16:17], s[18:19]
    s_cbranch_scc1 L_exact
L_exact_done:
    ds_read_b64_tr_b16 a[72:73], v3 offset:22528
    ds_read_b64_tr_b16 a[74:75], v3 offset:23552
    ds_read_b64_tr_b16 a[76:77], v4 offset:22528
    ds_read_b64_tr_b16 a[78:79], v4 offset:23552
    ds_read_b64_tr_b16 a[80:81], v3 offset:24576
    ds_read_b64_tr_b16 a[82:83], v3 offset:25600
    ds_read_b64_tr_b16 a[84:85], v4 offset:24576
    ds_read_b64_tr_b16 a[86:87], v4 offset:25600
    s_waitcnt vmcnt(29) lgkmcnt(6)
    v_mfma_f32_32x32x16_bf16 v[128:143], a[72:75], a[24:27], 0
    ds_read_b64_tr_b16 a[88:89], v3 offset:30720
    ds_read_b64_tr_b16 a[90:91], v3 offset:31744
    ds_read_b64_tr_b16 a[92:93], v4 offset:30720
    ds_read_b64_tr_b16 a[94:95], v4 offset:31744
    s_waitcnt lgkmcnt(8)
    v_mfma_f32_32x32x16_bf16 v[144:159], a[76:79], a[24:27], 0
    s_waitcnt vmcnt(28)
    v_mfma_f32_32x32x16_bf16 v[160:175], a[72:75], a[28:31], 0
    s_add_u32 s1, s8, 4096
    buffer_load_dwordx4 a[200:203], v25, s[12:15], s1 offen offset:0 sc1
    buffer_load_dwordx4 a[204:207], v26, s[12:15], s1 offen offset:0 sc1
    v_mfma_f32_32x32x16_bf16 v[176:191], a[76:79], a[28:31], 0
    s_waitcnt vmcnt(29) lgkmcnt(6)
    v_mfma_f32_32x32x16_bf16 v[128:143], a[80:83], a[32:35], v[128:143]
    ds_read_b64_tr_b16 a[96:97], v3 offset:32768
    ds_read_b64_tr_b16 a[98:99], v3 offset:33792
    ds_read_b64_tr_b16 a[100:101], v4 offset:32768
    ds_read_b64_tr_b16 a[102:103], v4 offset:33792
    s_waitcnt lgkmcnt(8)
    v_mfma_f32_32x32x16_bf16 v[144:159], a[84:87], a[32:35], v[144:159]
    s_waitcnt vmcnt(28)
    v_mfma_f32_32x32x16_bf16 v[160:175], a[80:83], a[36:39], v[160:175]
    v_mfma_f32_32x32x16_bf16 v[176:191], a[84:87], a[36:39], v[176:191]
    buffer_load_dwordx4 a[208:211], v25, s[12:15], s1 offen offset:2048 sc1
    buffer_load_dwordx4 a[212:215], v26, s[12:15], s1 offen offset:2048 sc1
    s_waitcnt vmcnt(29) lgkmcnt(6)
    v_mfma_f32_32x32x16_bf16 v[128:143], a[88:91], a[40:43], v[128:143]
    ds_read_b64_tr_b16 a[72:73], v3 offset:34816
    ds_read_b64_tr_b16 a[74:75], v3 offset:35840
    ds_read_b64_tr_b16 a[76:77], v4 offset:34816
    ds_read_b64_tr_b16 a[78:79], v4 offset:35840
    s_add_u32 s57, s8, 16384
    s_waitcnt lgkmcnt(8)
    v_mfma_f32_32x32x16_bf16 v[144:159], a[92:95], a[40:43], v[144:159]
    buffer_load_dwordx4 a[24:27], v25, s[12:15], s57 offen offset:0 sc1
    buffer_load_dwordx4 a[28:31], v26, s[12:15], s57 offen offset:0 sc1
    buffer_load_dwordx4 a[32:35], v25, s[12:15], s57 offen offset:2048 sc1
    s_waitcnt vmcnt(31)
    v_mfma_f32_32x32x16_bf16 v[160:175], a[88:91], a[44:47], v[160:175]
    buffer_load_dwordx4 a[36:39], v26, s[12:15], s57 offen offset:2048 sc1
    s_waitcnt vmcnt(8)
    v_mfma_f32_32x32x16_bf16 v[176:191], a[92:95], a[44:47], v[176:191]
    s_add_u32 s56, s58, 16384
    s_mov_b64 exec, 1
    buffer_store_dwordx2 v[6:7], off, s[28:31], s56 sc0 sc1
    s_mov_b64 exec, -1
    s_waitcnt lgkmcnt(6)
    v_mfma_f32_32x32x16_bf16 v[128:143], a[96:99], a[48:51], v[128:143]
    ds_read_b64_tr_b16 a[80:81], v3 offset:36864
    ds_read_b64_tr_b16 a[82:83], v3 offset:37888
    ds_read_b64_tr_b16 a[84:85], v4 offset:36864
    ds_read_b64_tr_b16 a[86:87], v4 offset:37888
    s_waitcnt lgkmcnt(8)
    v_mfma_f32_32x32x16_bf16 v[144:159], a[100:103], a[48:51], v[144:159]
    v_mfma_f32_32x32x16_bf16 v[160:175], a[96:99], a[52:55], v[160:175]
    v_mfma_f32_32x32x16_bf16 v[176:191], a[100:103], a[52:55], v[176:191]
    s_waitcnt lgkmcnt(6)
    v_mfma_f32_32x32x16_bf16 v[128:143], a[72:75], a[56:59], v[128:143]
    ds_read_b64_tr_b16 a[88:89], v3 offset:26624
    ds_read_b64_tr_b16 a[90:91], v3 offset:27648
    ds_read_b64_tr_b16 a[92:93], v4 offset:26624
    ds_read_b64_tr_b16 a[94:95], v4 offset:27648
    s_waitcnt lgkmcnt(8)
    v_mfma_f32_32x32x16_bf16 v[144:159], a[76:79], a[56:59], v[144:159]
    v_mfma_f32_32x32x16_bf16 v[160:175], a[72:75], a[60:63], v[160:175]
    v_mfma_f32_32x32x16_bf16 v[176:191], a[76:79], a[60:63], v[176:191]
    s_waitcnt lgkmcnt(6)
    v_mfma_f32_32x32x16_bf16 v[128:143], a[80:83], a[64:67], v[128:143]
    ds_read_b64_tr_b16 a[96:97], v3 offset:28672
    ds_read_b64_tr_b16 a[98:99], v3 offset:29696
    ds_read_b64_tr_b16 a[100:101], v4 offset:28672
    ds_read_b64_tr_b16 a[102:103], v4 offset:29696
    v_and_b32_e64 v96, 31, v0
    s_waitcnt lgkmcnt(8)
    v_mfma_f32_32x32x16_bf16 v[144:159], a[84:87], a[64:67], v[144:159]
    s_lshr_b32 s54, s98, 3
    s_and_b32 s55, s3, 1
    s_lshl_b32 s55, s55, 7
    s_add_u32 s54, s54, s55
    s_add_u32 s55, s54, 162816
    v_lshl_add_u32 v97, v96, 2, s55
    v_mfma_f32_32x32x16_bf16 v[160:175], a[80:83], a[68:71], v[160:175]
    s_lshl_b32 s11, s4, 17
    s_lshl_b32 s54, s54, 8
    ds_read_b32 v98, v97
    s_add_u32 s11, s11, s54
    s_lshr_b32 s54, s5, 1
    s_lshl_b32 s54, s54, 7
    v_mfma_f32_32x32x16_bf16 v[176:191], a[84:87], a[68:71], v[176:191]
    s_add_u32 s11, s11, s54
    s_lshr_b32 s54, s3, 1
    s_lshl_b32 s55, s54, 6
    s_add_u32 s11, s11, s55
    v_lshrrev_b32 v97, 5, v0
    v_lshlrev_b32 v97, 4, v97
    s_waitcnt lgkmcnt(7)
    v_mfma_f32_32x32x16_bf16 v[128:143], a[88:91], v[80:83], v[128:143]
    ds_read_b64_tr_b16 a[72:73], v3 offset:14336
    ds_read_b64_tr_b16 a[74:75], v3 offset:15360
    ds_read_b64_tr_b16 a[76:77], v4 offset:14336
    ds_read_b64_tr_b16 a[78:79], v4 offset:15360
    v_lshl_add_u32 v110, v96, 10, v97
    s_waitcnt lgkmcnt(9)
    v_mfma_f32_32x32x16_bf16 v[144:159], a[92:95], v[80:83], v[144:159]
    s_mul_i32 s54, s54, 81920
    s_sub_u32 s54, s54, s7
    v_add_u32 v106, s54, v3
    v_add_u32 v107, s54, v4
    v_add_u32 v108, 40960, v106
    v_add_u32 v109, 40960, v107
    v_mfma_f32_32x32x16_bf16 v[160:175], a[88:91], v[84:87], v[160:175]
    s_add_u32 s1, s8, 8192
    buffer_load_dwordx4 a[216:219], v25, s[12:15], s1 offen offset:0 sc1
    buffer_load_dwordx4 a[220:223], v26, s[12:15], s1 offen offset:0 sc1
    v_add_u32 v105, s7, v24
    s_xor_b32 s54, s3, 2
    s_mul_i32 s54, s54, 40960
    v_add_u32 v102, s54, v24
    s_xor_b32 s54, s3, 1
    s_mul_i32 s54, s54, 40960
    v_mfma_f32_32x32x16_bf16 v[176:191], a[92:95], v[84:87], v[176:191]
    v_add_u32 v103, s54, v24
    s_xor_b32 s54, s3, 3
    s_mul_i32 s54, s54, 40960
    v_add_u32 v104, s54, v24
    v_lshrrev_b32 v97, 1, v97
    v_add3_u32 v97, v97, s7, 0
    s_waitcnt lgkmcnt(7)
    v_mfma_f32_32x32x16_bf16 v[128:143], a[96:99], v[88:91], v[128:143]
    ds_read_b64_tr_b16 a[80:81], v3 offset:16384
    ds_read_b64_tr_b16 a[82:83], v3 offset:17408
    ds_read_b64_tr_b16 a[84:85], v4 offset:16384
    ds_read_b64_tr_b16 a[86:87], v4 offset:17408
    v_add_u32_e64 v97, s55, v97
    s_waitcnt lgkmcnt(9)
    v_mfma_f32_32x32x16_bf16 v[144:159], a[100:103], v[88:91], v[144:159]
    ds_read_b64 v[114:115], v97 offset:40704
    ds_read_b64 v[118:119], v97 offset:40720
    ds_read_b64 v[122:123], v97 offset:40736
    ds_read_b64 v[126:127], v97 offset:40752
    s_waitcnt lgkmcnt(3)
    v_lshlrev_b32 v112, 16, v114
    v_mfma_f32_32x32x16_bf16 v[160:175], a[96:99], v[92:95], v[160:175]
    buffer_load_dwordx4 a[224:227], v25, s[12:15], s1 offen offset:2048 sc1
    buffer_load_dwordx4 a[228:231], v26, s[12:15], s1 offen offset:2048 sc1
    v_and_b32 v113, 0xffff0000, v114
    v_lshlrev_b32_e64 v114, 16, v115
    v_and_b32 v115, 0xffff0000, v115
    s_waitcnt lgkmcnt(2)
    v_lshlrev_b32 v116, 16, v118
    v_and_b32 v117, 0xffff0000, v118
    v_lshlrev_b32_e64 v118, 16, v119
    v_mfma_f32_32x32x16_bf16 v[176:191], a[100:103], v[92:95], v[176:191]
    v_and_b32 v119, 0xffff0000, v119
    s_waitcnt lgkmcnt(1)
    v_lshlrev_b32 v120, 16, v122
    v_and_b32 v121, 0xffff0000, v122
    v_lshlrev_b32_e64 v122, 16, v123
    v_and_b32 v123, 0xffff0000, v123
    s_waitcnt lgkmcnt(0)
    v_lshlrev_b32 v124, 16, v126
    v_mfma_f32_32x32x16_bf16 v[128:143], a[72:75], v[192:195], v[128:143]
    s_barrier
    ds_read_b64_tr_b16 a[88:89], v3 offset:18432
    ds_read_b64_tr_b16 a[90:91], v3 offset:19456
    ds_read_b64_tr_b16 a[92:93], v4 offset:18432
    ds_read_b64_tr_b16 a[94:95], v4 offset:19456
    v_mfma_f32_32x32x16_bf16 v[144:159], a[76:79], v[192:195], v[144:159]
    s_add_u32 s1, s8, 12288
    buffer_load_dwordx4 a[232:235], v25, s[12:15], s1 offen offset:0 sc1
    buffer_load_dwordx4 a[236:239], v26, s[12:15], s1 offen offset:0 sc1
    v_and_b32 v125, 0xffff0000, v126
    v_lshlrev_b32 v126, 16, v127
    v_and_b32 v127, 0xffff0000, v127
    s_and_b32 s54, s3, 1
    s_mul_i32 s54, s54, 4608
    s_lshr_b32 s55, s3, 1
    v_mfma_f32_32x32x16_bf16 v[160:175], a[72:75], v[196:199], v[160:175]
    s_lshl_b32 s55, s55, 6
    s_add_u32 s54, s54, s55
    v_mul_u32_u24 v99, 144, v96
    v_lshrrev_b32_e64 v101, 5, v0
    v_lshl_add_u32 v99, v101, 4, v99
    v_add_u32_e64 v99, s54, v99
    v_mfma_f32_32x32x16_bf16 v[176:191], a[76:79], v[196:199], v[176:191]
    v_lshrrev_b32_e64 v96, 3, v0
    v_lshl_add_u32 v96, s3, 4, v96
    v_and_b32_e64 v111, 7, v0
    v_mul_u32_u24 v101, 144, v96
    v_lshl_add_u32 v101, v111, 4, v101
    v_lshlrev_b32_e64 v110, 10, v96
    v_mfma_f32_32x32x16_bf16 v[128:143], a[80:83], v[200:203], v[128:143]
    ds_read_b64_tr_b16 a[96:97], v3 offset:20480
    ds_read_b64_tr_b16 a[98:99], v3 offset:21504
    ds_read_b64_tr_b16 a[100:101], v4 offset:20480
    ds_read_b64_tr_b16 a[102:103], v4 offset:21504
    v_lshl_add_u32 v110, v111, 4, v110
    v_mfma_f32_32x32x16_bf16 v[144:159], a[84:87], v[200:203], v[144:159]
    buffer_load_dwordx4 a[240:243], v25, s[12:15], s1 offen offset:2048 sc1
    buffer_load_dwordx4 a[244:247], v26, s[12:15], s1 offen offset:2048 sc1
    s_lshl_b32 s11, s4, 17
    s_lshl_b32 s54, s98, 5
    s_add_u32 s11, s11, s54
    s_lshr_b32 s54, s5, 1
    s_lshl_b32 s54, s54, 7
    s_add_u32 s11, s11, s54
    v_mfma_f32_32x32x16_bf16 v[160:175], a[80:83], v[204:207], v[160:175]
    v_sub_f32_e64 v100, 1.0, v98
    v_cvt_pk_bf16_f32 v100, v100, v100
    v_lshlrev_b32_e64 v100, 16, v100
    v_mfma_f32_32x32x16_bf16 v[176:191], a[84:87], v[204:207], v[176:191]
    s_waitcnt lgkmcnt(6)
    v_mfma_f32_32x32x16_bf16 v[128:143], a[88:91], v[208:211], v[128:143]
    s_waitcnt lgkmcnt(4)
    v_mfma_f32_32x32x16_bf16 v[144:159], a[92:95], v[208:211], v[144:159]
    s_add_u32 m0, s7, 22528
    s_add_u32 s96, s99, 0
    buffer_load_dwordx4 v1, s[24:27], s96 offen offset:0 lds
    buffer_load_dwordx4 v2, s[24:27], s96 offen offset:1024 lds
    v_mfma_f32_32x32x16_bf16 v[160:175], a[88:91], v[212:215], v[160:175]
    v_mfma_f32_32x32x16_bf16 v[176:191], a[92:95], v[212:215], v[176:191]
    s_waitcnt lgkmcnt(2)
    v_mfma_f32_32x32x16_bf16 v[128:143], a[96:99], v[216:219], v[128:143]
    s_waitcnt lgkmcnt(0)
    v_mfma_f32_32x32x16_bf16 v[144:159], a[100:103], v[216:219], v[144:159]
    buffer_load_dwordx4 v12, s[24:27], s96 offen offset:2048 lds
    buffer_load_dwordx4 v22, s[24:27], s96 offen offset:3072 lds
    v_mfma_f32_32x32x16_bf16 v[160:175], a[96:99], v[220:223], v[160:175]
    v_mfma_f32_32x32x16_bf16 v[176:191], a[100:103], v[220:223], v[176:191]
    v_mfma_f32_32x32x16_bf16 v[128:143], a[104:107], a[184:187], v[128:143]
    v_mfma_f32_32x32x16_bf16 v[144:159], a[108:111], a[184:187], v[144:159]
    v_mfma_f32_32x32x16_bf16 v[160:175], a[104:107], a[188:191], v[160:175]
    s_add_u32 m0, s7, 30720
    s_add_u32 s96, s99, 32768
    buffer_load_dwordx4 v1, s[24:27], s96 offen offset:0 lds
    buffer_load_dwordx4 v2, s[24:27], s96 offen offset:1024 lds
    v_mfma_f32_32x32x16_bf16 v[176:191], a[108:111], a[188:191], v[176:191]
    v_mfma_f32_32x32x16_bf16 v[128:143], a[112:115], a[192:195], v[128:143]
    buffer_load_dwordx2 v[8:9], v13, s[28:31], s10 offen sc1
    v_mfma_f32_32x32x16_bf16 v[144:159], a[116:119], a[192:195], v[144:159]
    v_mfma_f32_32x32x16_bf16 v[160:175], a[112:115], a[196:199], v[160:175]
    v_mfma_f32_32x32x16_bf16 v[176:191], a[116:119], a[196:199], v[176:191]
    buffer_load_dwordx4 v12, s[24:27], s96 offen offset:2048 lds
    buffer_load_dwordx4 v22, s[24:27], s96 offen offset:3072 lds
    s_waitcnt vmcnt(25)
    v_mfma_f32_32x32x16_bf16 v[128:143], a[120:123], a[200:203], v[128:143]
    v_mfma_f32_32x32x16_bf16 v[144:159], a[124:127], a[200:203], v[144:159]
    s_waitcnt vmcnt(24)
    v_mfma_f32_32x32x16_bf16 v[160:175], a[120:123], a[204:207], v[160:175]
    v_mfma_f32_32x32x16_bf16 v[176:191], a[124:127], a[204:207], v[176:191]
    s_waitcnt vmcnt(23)
    v_mfma_f32_32x32x16_bf16 v[128:143], a[128:131], a[208:211], v[128:143]
    v_mfma_f32_32x32x16_bf16 v[144:159], a[132:135], a[208:211], v[144:159]
    s_waitcnt vmcnt(22)
    v_mfma_f32_32x32x16_bf16 v[160:175], a[128:131], a[212:215], v[160:175]
    v_mfma_f32_32x32x16_bf16 v[176:191], a[132:135], a[212:215], v[176:191]
    s_add_u32 m0, s7, 34816
    s_add_u32 s96, s99, 65536
    buffer_load_dwordx4 v1, s[24:27], s96 offen offset:0 lds
    buffer_load_dwordx4 v2, s[24:27], s96 offen offset:1024 lds
    buffer_load_dwordx4 v12, s[24:27], s96 offen offset:2048 lds
    buffer_load_dwordx4 v22, s[24:27], s96 offen offset:3072 lds
    s_add_u32 m0, s7, 26624
    s_add_u32 s96, s99, 98304
    buffer_load_dwordx4 v1, s[24:27], s96 offen offset:0 lds
    buffer_load_dwordx4 v2, s[24:27], s96 offen offset:1024 lds
    buffer_load_dwordx4 v12, s[24:27], s96 offen offset:2048 lds
    buffer_load_dwordx4 v22, s[24:27], s96 offen offset:3072 lds
    s_waitcnt vmcnt(10)
    v_cmp_ne_u64 vcc, s[52:53], v[8:9]
    s_nop 0
    s_cmp_eq_u64 vcc, 0
    s_cbranch_scc0 Lpoll_7
Lpollb_8:
    v_mfma_f32_32x32x16_bf16 v[176:191], a[140:143], a[220:223], v[176:191]
    s_add_u32 s57, s9, 0
    buffer_load_dwordx4 v[32:35], v25, s[40:43], s57 offen sc1
    v_mfma_f32_32x32x16_bf16 v[176:191], a[148:151], a[228:231], v[176:191]
    s_add_u32 s57, s9, 4096
    buffer_load_dwordx4 v[36:39], v25, s[40:43], s57 offen sc1
    v_mfma_f32_32x32x16_bf16 v[176:191], a[156:159], a[236:239], v[176:191]
    s_add_u32 s57, s9, 8192
    buffer_load_dwordx4 v[40:43], v25, s[40:43], s57 offen sc1
    v_mfma_f32_32x32x16_bf16 v[176:191], a[164:167], a[244:247], v[176:191]
    s_add_u32 s57, s9, 12288
    buffer_load_dwordx4 v[44:47], v25, s[40:43], s57 offen sc1
    v_mfma_f32_32x32x16_bf16 v[176:191], a[172:175], a[28:31], v[176:191]
    v_mfma_f32_32x32x16_bf16 v[176:191], a[180:183], a[36:39], v[176:191]
    v_mfma_f32_32x32x16_bf16 v[160:175], a[136:139], a[220:223], v[160:175]
    s_add_u32 s57, s9, 16384
    buffer_load_dwordx4 v[48:51], v25, s[40:43], s57 offen sc1
    v_mfma_f32_32x32x16_bf16 v[160:175], a[144:147], a[228:231], v[160:175]
    s_nop 7
    ds_write_b128 v104, v[176:179] offset:8192
    v_mfma_f32_32x32x16_bf16 v[160:175], a[152:155], a[236:239], v[160:175]
    ds_write_b128 v104, v[180:183] offset:9216
    s_add_u32 s57, s9, 20480
    buffer_load_dwordx4 v[52:55], v25, s[40:43], s57 offen sc1
    v_mfma_f32_32x32x16_bf16 v[160:175], a[160:163], a[244:247], v[160:175]
    ds_write_b128 v104, v[184:187] offset:10240
    s_add_u32 s57, s9, 24576
    buffer_load_dwordx4 v[56:59], v25, s[40:43], s57 offen sc1
    v_mfma_f32_32x32x16_bf16 v[160:175], a[168:171], a[28:31], v[160:175]
    ds_write_b128 v104, v[188:191] offset:11264
    s_add_u32 s57, s9, 28672
    buffer_load_dwordx4 v[60:63], v25, s[40:43], s57 offen sc1
    v_mfma_f32_32x32x16_bf16 v[160:175], a[176:179], a[36:39], v[160:175]
    s_waitcnt vmcnt(8)
    s_barrier
    v_mfma_f32_32x32x16_bf16 v[144:159], a[140:143], a[216:219], v[144:159]
    s_add_u32 s57, s9, 32768
    buffer_load_dwordx4 v[64:67], v25, s[40:43], s57 offen sc1
    v_mfma_f32_32x32x16_bf16 v[144:159], a[148:151], a[224:227], v[144:159]
    s_nop 5
    ds_write_b128 v103, v[160:163] offset:4096
    v_mfma_f32_32x32x16_bf16 v[144:159], a[156:159], a[232:235], v[144:159]
    ds_write_b128 v103, v[164:167] offset:5120
    s_add_u32 s57, s9, 36864
    buffer_load_dwordx4 v[68:71], v25, s[40:43], s57 offen sc1
    v_mfma_f32_32x32x16_bf16 v[144:159], a[164:167], a[240:243], v[144:159]
    ds_write_b128 v103, v[168:171] offset:6144
    s_add_u32 s57, s9, 40960
    buffer_load_dwordx4 v[72:75], v25, s[40:43], s57 offen sc1
    v_mfma_f32_32x32x16_bf16 v[144:159], a[172:175], a[24:27], v[144:159]
    ds_write_b128 v103, v[172:175] offset:7168
    s_add_u32 s57, s9, 45056
    buffer_load_dwordx4 v[76:79], v25, s[40:43], s57 offen sc1
    v_mfma_f32_32x32x16_bf16 v[144:159], a[180:183], a[32:35], v[144:159]
    v_mfma_f32_32x32x16_bf16 v[128:143], a[136:139], a[216:219], v[128:143]
    s_add_u32 s57, s9, 49152
    buffer_load_dwordx4 v[80:83], v25, s[40:43], s57 offen sc1
    v_mfma_f32_32x32x16_bf16 v[128:143], a[144:147], a[224:227], v[128:143]
    s_nop 7
    ds_write_b128 v102, v[144:147] offset:0
    v_mfma_f32_32x32x16_bf16 v[128:143], a[152:155], a[232:235], v[128:143]
    ds_write_b128 v102, v[148:151] offset:1024
    s_add_u32 s57, s9, 53248
    buffer_load_dwordx4 v[84:87], v25, s[40:43], s57 offen sc1
    v_mfma_f32_32x32x16_bf16 v[128:143], a[160:163], a[240:243], v[128:143]
    ds_write_b128 v102, v[152:155] offset:2048
    s_add_u32 s57, s9, 57344
    buffer_load_dwordx4 v[88:91], v25, s[40:43], s57 offen sc1
    v_mfma_f32_32x32x16_bf16 v[128:143], a[168:171], a[24:27], v[128:143]
    ds_write_b128 v102, v[156:159] offset:3072
    s_add_u32 s57, s9, 61440
    buffer_load_dwordx4 v[92:95], v25, s[40:43], s57 offen sc1
    v_mfma_f32_32x32x16_bf16 v[128:143], a[176:179], a[32:35], v[128:143]
    ds_read_b64_tr_b16 a[72:73], v107 offset:22528
    ds_read_b64_tr_b16 a[74:75], v107 offset:23552
    ds_read_b64_tr_b16 a[76:77], v107 offset:24576
    ds_read_b64_tr_b16 a[78:79], v107 offset:25600
    ds_read_b64_tr_b16 a[80:81], v107 offset:30720
    ds_read_b64_tr_b16 a[82:83], v107 offset:31744
    ds_read_b64_tr_b16 a[84:85], v107 offset:32768
    ds_read_b64_tr_b16 a[86:87], v107 offset:33792
    s_waitcnt vmcnt(15) lgkmcnt(6)
    v_mfma_f32_32x32x16_bf16 v[208:223], a[72:75], v[32:35], 0
    ds_read_b64_tr_b16 a[88:89], v107 offset:34816
    ds_read_b64_tr_b16 a[90:91], v107 offset:35840
    v_add_f32 v128, v128, v112
    v_add_f32 v129, v129, v113
    v_add_f32_e64 v130, v130, v114
    s_waitcnt vmcnt(14) lgkmcnt(6)
    v_mfma_f32_32x32x16_bf16 v[208:223], a[76:79], v[36:39], v[208:223]
    ds_read_b64_tr_b16 a[92:93], v107 offset:36864
    ds_read_b64_tr_b16 a[94:95], v107 offset:37888
    v_add_f32 v131, v131, v115
    v_add_f32 v132, v132, v116
    v_add_f32 v133, v133, v117
    s_waitcnt vmcnt(13) lgkmcnt(6)
    v_mfma_f32_32x32x16_bf16 v[208:223], a[80:83], v[40:43], v[208:223]
    ds_read_b64_tr_b16 a[96:97], v107 offset:26624
    ds_read_b64_tr_b16 a[98:99], v107 offset:27648
    s_barrier
    s_waitcnt vmcnt(12) lgkmcnt(6)
    v_mfma_f32_32x32x16_bf16 v[208:223], a[84:87], v[44:47], v[208:223]
    ds_read_b64_tr_b16 a[100:101], v107 offset:28672
    ds_read_b64_tr_b16 a[102:103], v107 offset:29696
    ds_read_b128 v[144:147], v105 offset:0
    v_add_f32 v134, v134, v118
    s_waitcnt vmcnt(11) lgkmcnt(7)
    v_mfma_f32_32x32x16_bf16 v[208:223], a[88:91], v[48:51], v[208:223]
    ds_read_b64_tr_b16 a[72:73], v109 offset:22528
    ds_read_b64_tr_b16 a[74:75], v109 offset:23552
    ds_read_b128 v[148:151], v105 offset:1024
    v_add_f32 v135, v135, v119
    s_waitcnt vmcnt(10) lgkmcnt(8)
    v_mfma_f32_32x32x16_bf16 v[208:223], a[92:95], v[52:55], v[208:223]
    ds_read_b64_tr_b16 a[76:77], v109 offset:24576
    ds_read_b64_tr_b16 a[78:79], v109 offset:25600
    ds_read_b128 v[152:155], v105 offset:2048
    v_add_f32 v136, v136, v120
    s_waitcnt vmcnt(9) lgkmcnt(9)
    v_mfma_f32_32x32x16_bf16 v[208:223], a[96:99], v[56:59], v[208:223]
    ds_read_b64_tr_b16 a[80:81], v109 offset:30720
    ds_read_b64_tr_b16 a[82:83], v109 offset:31744
    ds_read_b128 v[156:159], v105 offset:3072
    v_add_f32 v137, v137, v121
    s_waitcnt vmcnt(8) lgkmcnt(10)
    v_mfma_f32_32x32x16_bf16 v[208:223], a[100:103], v[60:63], v[208:223]
    ds_read_b64_tr_b16 a[84:85], v109 offset:32768
    ds_read_b64_tr_b16 a[86:87], v109 offset:33792
    ds_read_b128 v[160:163], v105 offset:4096
    v_add_f32 v138, v138, v122
    s_waitcnt vmcnt(7) lgkmcnt(10)
    v_mfma_f32_32x32x16_bf16 v[208:223], a[72:75], v[64:67], v[208:223]
    ds_read_b64_tr_b16 a[88:89], v109 offset:34816
    ds_read_b64_tr_b16 a[90:91], v109 offset:35840
    ds_read_b128 v[164:167], v105 offset:5120
    v_add_f32 v139, v139, v123
    s_waitcnt vmcnt(6) lgkmcnt(10)
    v_mfma_f32_32x32x16_bf16 v[208:223], a[76:79], v[68:71], v[208:223]
    ds_read_b64_tr_b16 a[92:93], v109 offset:36864
    ds_read_b64_tr_b16 a[94:95], v109 offset:37888
    ds_read_b128 v[168:171], v105 offset:6144
    v_add_f32 v140, v140, v124
    s_waitcnt vmcnt(5) lgkmcnt(10)
    v_mfma_f32_32x32x16_bf16 v[208:223], a[80:83], v[72:75], v[208:223]
    ds_read_b64_tr_b16 a[96:97], v109 offset:26624
    ds_read_b64_tr_b16 a[98:99], v109 offset:27648
    ds_read_b128 v[172:175], v105 offset:7168
    v_add_f32 v141, v141, v125
    s_waitcnt vmcnt(4) lgkmcnt(10)
    v_mfma_f32_32x32x16_bf16 v[208:223], a[84:87], v[76:79], v[208:223]
    ds_read_b64_tr_b16 a[100:101], v109 offset:28672
    ds_read_b64_tr_b16 a[102:103], v109 offset:29696
    ds_read_b128 v[176:179], v105 offset:8192
    v_add_f32 v142, v142, v126
    s_waitcnt vmcnt(3) lgkmcnt(10)
    v_mfma_f32_32x32x16_bf16 v[208:223], a[88:91], v[80:83], v[208:223]
    ds_read_b64_tr_b16 a[72:73], v106 offset:22528
    ds_read_b64_tr_b16 a[74:75], v106 offset:23552
    ds_read_b128 v[180:183], v105 offset:9216
    v_add_f32 v143, v143, v127
    s_waitcnt vmcnt(2) lgkmcnt(10)
    v_mfma_f32_32x32x16_bf16 v[208:223], a[92:95], v[84:87], v[208:223]
    ds_read_b64_tr_b16 a[76:77], v106 offset:24576
    ds_read_b64_tr_b16 a[78:79], v106 offset:25600
    ds_read_b128 v[184:187], v105 offset:10240
    s_waitcnt vmcnt(1) lgkmcnt(10)
    v_mfma_f32_32x32x16_bf16 v[208:223], a[96:99], v[88:91], v[208:223]
    ds_read_b64_tr_b16 a[80:81], v106 offset:30720
    ds_read_b64_tr_b16 a[82:83], v106 offset:31744
    ds_read_b128 v[188:191], v105 offset:11264
    s_waitcnt vmcnt(0) lgkmcnt(10)
    v_mfma_f32_32x32x16_bf16 v[208:223], a[100:103], v[92:95], v[208:223]
    ds_read_b64_tr_b16 a[84:85], v106 offset:32768
    ds_read_b64_tr_b16 a[86:87], v106 offset:33792
    s_waitcnt lgkmcnt(9)
    v_mfma_f32_32x32x16_bf16 v[192:207], a[72:75], v[32:35], 0
    ds_read_b64_tr_b16 a[88:89], v106 offset:34816
    ds_read_b64_tr_b16 a[90:91], v106 offset:35840
    v_add_f32 v128, v128, v144
    v_add_f32 v129, v129, v145
    v_add_f32_e64 v130, v130, v146
    s_waitcnt lgkmcnt(8)
    v_mfma_f32_32x32x16_bf16 v[192:207], a[76:79], v[36:39], v[192:207]
    ds_read_b64_tr_b16 a[92:93], v106 offset:36864
    ds_read_b64_tr_b16 a[94:95], v106 offset:37888
    v_add_f32 v131, v131, v147
    v_add_f32 v132, v132, v148
    v_add_f32 v133, v133, v149
    s_waitcnt lgkmcnt(7)
    v_mfma_f32_32x32x16_bf16 v[192:207], a[80:83], v[40:43], v[192:207]
    ds_read_b64_tr_b16 a[96:97], v106 offset:26624
    ds_read_b64_tr_b16 a[98:99], v106 offset:27648
    v_add_f32 v134, v134, v150
    v_add_f32 v135, v135, v151
    v_add_f32 v136, v136, v152
    s_waitcnt lgkmcnt(6)
    v_mfma_f32_32x32x16_bf16 v[192:207], a[84:87], v[44:47], v[192:207]
    ds_read_b64_tr_b16 a[100:101], v106 offset:28672
    ds_read_b64_tr_b16 a[102:103], v106 offset:29696
    ds_write_b128 v102, v[208:211] offset:18432
    v_add_f32 v137, v137, v153
    v_add_f32_e64 v138, v138, v154
    s_waitcnt lgkmcnt(7)
    v_mfma_f32_32x32x16_bf16 v[192:207], a[88:91], v[48:51], v[192:207]
    ds_read_b64_tr_b16 a[72:73], v108 offset:22528
    ds_read_b64_tr_b16 a[74:75], v108 offset:23552
    ds_write_b128 v102, v[212:215] offset:19456
    v_add_f32 v139, v139, v155
    v_add_f32_e64 v140, v140, v156
    s_waitcnt lgkmcnt(8)
    v_mfma_f32_32x32x16_bf16 v[192:207], a[92:95], v[52:55], v[192:207]
    ds_read_b64_tr_b16 a[76:77], v108 offset:24576
    ds_read_b64_tr_b16 a[78:79], v108 offset:25600
    ds_write_b128 v102, v[216:219] offset:20480
    v_add_f32 v141, v141, v157
    v_add_f32_e64 v142, v142, v158
    s_waitcnt lgkmcnt(9)
    v_mfma_f32_32x32x16_bf16 v[192:207], a[96:99], v[56:59], v[192:207]
    ds_read_b64_tr_b16 a[80:81], v108 offset:30720
    ds_read_b64_tr_b16 a[82:83], v108 offset:31744
    ds_write_b128 v102, v[220:223] offset:21504
    v_add_f32 v143, v143, v159
    v_add_f32_e64 v160, v160, v176
    s_waitcnt lgkmcnt(10)
    v_mfma_f32_32x32x16_bf16 v[192:207], a[100:103], v[60:63], v[192:207]
    ds_read_b64_tr_b16 a[84:85], v108 offset:32768
    ds_read_b64_tr_b16 a[86:87], v108 offset:33792
    v_add_f32 v161, v161, v177
    v_add_f32 v162, v162, v178
    v_add_f32 v163, v163, v179
    s_waitcnt lgkmcnt(9)
    v_mfma_f32_32x32x16_bf16 v[192:207], a[72:75], v[64:67], v[192:207]
    ds_read_b64_tr_b16 a[88:89], v108 offset:34816
    ds_read_b64_tr_b16 a[90:91], v108 offset:35840
    v_add_f32 v164, v164, v180
    v_add_f32 v165, v165, v181
    v_add_f32 v166, v166, v182
    s_waitcnt lgkmcnt(8)
    v_mfma_f32_32x32x16_bf16 v[192:207], a[76:79], v[68:71], v[192:207]
    ds_read_b64_tr_b16 a[92:93], v108 offset:36864
    ds_read_b64_tr_b16 a[94:95], v108 offset:37888
    v_add_f32 v167, v167, v183
    v_add_f32 v168, v168, v184
    v_add_f32 v169, v169, v185
    s_waitcnt lgkmcnt(7)
    v_mfma_f32_32x32x16_bf16 v[192:207], a[80:83], v[72:75], v[192:207]
    ds_read_b64_tr_b16 a[96:97], v108 offset:26624
    ds_read_b64_tr_b16 a[98:99], v108 offset:27648
    s_waitcnt lgkmcnt(8)
    s_barrier
    s_waitcnt lgkmcnt(6)
    v_mfma_f32_32x32x16_bf16 v[192:207], a[84:87], v[76:79], v[192:207]
    ds_read_b64_tr_b16 a[100:101], v108 offset:28672
    ds_read_b64_tr_b16 a[102:103], v108 offset:29696
    ds_read_b128 v[224:227], v105 offset:18432
    ds_read_b128 v[228:231], v105 offset:19456
    ds_read_b128 v[232:235], v105 offset:20480
    s_waitcnt lgkmcnt(9)
    v_mfma_f32_32x32x16_bf16 v[192:207], a[88:91], v[80:83], v[192:207]
    ds_read_b128 v[236:239], v105 offset:21504
    v_add_f32 v170, v170, v186
    v_add_f32 v171, v171, v187
    v_add_f32 v172, v172, v188
    v_add_f32_e64 v173, v173, v189
    s_waitcnt lgkmcnt(8)
    v_mfma_f32_32x32x16_bf16 v[192:207], a[92:95], v[84:87], v[192:207]
    v_add_f32 v174, v174, v190
    v_add_f32_e64 v175, v175, v191
    s_waitcnt lgkmcnt(6)
    v_mfma_f32_32x32x16_bf16 v[192:207], a[96:99], v[88:91], v[192:207]
    s_waitcnt lgkmcnt(4)
    v_mfma_f32_32x32x16_bf16 v[192:207], a[100:103], v[92:95], v[192:207]
    s_add_u32 s10, s11, 8192
    v_pk_add_f32 v[128:129], v[128:129], v[160:161]
    v_pk_add_f32 v[130:131], v[130:131], v[162:163]
    v_pk_add_f32 v[132:133], v[132:133], v[164:165]
    v_pk_add_f32 v[134:135], v[134:135], v[166:167]
    v_pk_add_f32 v[136:137], v[136:137], v[168:169]
    v_pk_add_f32 v[138:139], v[138:139], v[170:171]
    v_pk_add_f32 v[140:141], v[140:141], v[172:173]
    v_pk_add_f32 v[142:143], v[142:143], v[174:175]
    v_pk_mul_f32 v[128:129], v[128:129], v[100:101] op_sel_hi:[1,0]
    v_pk_mul_f32 v[130:131], v[130:131], v[100:101] op_sel_hi:[1,0]
    v_pk_mul_f32 v[132:133], v[132:133], v[100:101] op_sel_hi:[1,0]
    v_pk_mul_f32 v[134:135], v[134:135], v[100:101] op_sel_hi:[1,0]
    v_pk_mul_f32 v[136:137], v[136:137], v[100:101] op_sel_hi:[1,0]
    v_pk_mul_f32 v[138:139], v[138:139], v[100:101] op_sel_hi:[1,0]
    v_pk_mul_f32 v[140:141], v[140:141], v[100:101] op_sel_hi:[1,0]
    v_pk_mul_f32 v[142:143], v[142:143], v[100:101] op_sel_hi:[1,0]
    s_waitcnt lgkmcnt(3)
    v_pk_add_f32 v[224:225], v[224:225], v[192:193]
    v_pk_add_f32 v[226:227], v[226:227], v[194:195]
    s_waitcnt lgkmcnt(2)
    v_pk_add_f32 v[228:229], v[228:229], v[196:197]
    v_pk_add_f32 v[230:231], v[230:231], v[198:199]
    s_waitcnt lgkmcnt(1)
    v_pk_add_f32 v[232:233], v[232:233], v[200:201]
    v_pk_add_f32 v[234:235], v[234:235], v[202:203]
    s_waitcnt lgkmcnt(0)
    v_pk_add_f32 v[236:237], v[236:237], v[204:205]
    v_pk_add_f32 v[238:239], v[238:239], v[206:207]
    v_pk_fma_f32 v[128:129], v[224:225], v[98:99], v[128:129] op_sel_hi:[1,0,1]
    v_pk_fma_f32 v[130:131], v[226:227], v[98:99], v[130:131] op_sel_hi:[1,0,1]
    v_pk_fma_f32 v[132:133], v[228:229], v[98:99], v[132:133] op_sel_hi:[1,0,1]
    v_pk_fma_f32 v[134:135], v[230:231], v[98:99], v[134:135] op_sel_hi:[1,0,1]
    v_cvt_pk_bf16_f32 v240, v128, v129
    v_cvt_pk_bf16_f32 v241, v130, v131
    v_cvt_pk_bf16_f32 v242, v132, v133
    v_cvt_pk_bf16_f32 v243, v134, v135
    s_nop 0
    v_permlane32_swap_b32 v240, v242
    v_permlane32_swap_b32 v241, v243
    ds_write_b128 v99, v[240:243] offset:0
    v_pk_fma_f32 v[136:137], v[232:233], v[98:99], v[136:137] op_sel_hi:[1,0,1]
    v_pk_fma_f32 v[138:139], v[234:235], v[98:99], v[138:139] op_sel_hi:[1,0,1]
    v_pk_fma_f32 v[140:141], v[236:237], v[98:99], v[140:141] op_sel_hi:[1,0,1]
    v_pk_fma_f32 v[142:143], v[238:239], v[98:99], v[142:143] op_sel_hi:[1,0,1]
    v_cvt_pk_bf16_f32 v244, v136, v137
    v_cvt_pk_bf16_f32 v245, v138, v139
    v_cvt_pk_bf16_f32 v246, v140, v141
    v_cvt_pk_bf16_f32 v247, v142, v143
    s_nop 0
    v_permlane32_swap_b32 v244, v246
    v_permlane32_swap_b32 v245, v247
    ds_write_b128 v99, v[244:247] offset:32
    s_waitcnt lgkmcnt(0)
    s_barrier
    ds_read_b128 v[224:227], v101
    ds_read_b128 v[228:231], v101 offset:1152
    s_waitcnt lgkmcnt(1)
    buffer_store_dwordx4 v[224:227], v110, s[44:47], s11 offen sc1
    s_waitcnt lgkmcnt(0)
    buffer_store_dwordx4 v[228:231], v110, s[44:47], s10 offen sc1
L_end:
    s_endpgm
L_kv_v:
    s_add_u32 m0, s7, 8192
    s_nop 0
    buffer_load_dwordx4 v1, s[8:11], s66 offen offset:0 lds
    buffer_load_dwordx4 v2, s[8:11], s66 offen offset:1024 lds
    buffer_load_dwordx4 v3, s[8:11], s66 offen offset:2048 lds
    buffer_load_dwordx4 v4, s[8:11], s66 offen offset:3072 lds
    s_add_u32 m0, s7, 20480
    s_nop 0
    buffer_load_dwordx4 v9, s[12:15], s74 offen offset:0 lds
    buffer_load_dwordx4 v10, s[12:15], s74 offen offset:1024 lds
    s_waitcnt vmcnt(12)
    s_waitcnt lgkmcnt(0)
    s_barrier
    ds_read_b128 v[128:131], v5 offset:0
    ds_read_b64_tr_b16 a[0:1], v13 offset:16384
    ds_read_b64_tr_b16 a[2:3], v13 offset:16896
    ds_read_b64_tr_b16 a[4:5], v16 offset:16384
    ds_read_b64_tr_b16 a[6:7], v16 offset:16896
    ds_read_b128 a[32:35], v23 offset:38912
    ds_read_b128 v[132:135], v6 offset:0
    ds_read_b64_tr_b16 a[8:9], v13 offset:57344
    ds_read_b64_tr_b16 a[10:11], v13 offset:57856
    ds_read_b64_tr_b16 a[12:13], v16 offset:57344
    ds_read_b64_tr_b16 a[14:15], v16 offset:57856
    ds_read_b128 a[36:39], v23 offset:38944
    s_waitcnt lgkmcnt(9)
    v_mfma_f32_32x32x16_bf16 v[32:47], v[128:131], a[0:3], 0
    ds_read_b128 v[136:139], v7 offset:0
    ds_read_b64_tr_b16 a[16:17], v14 offset:32768
    ds_read_b64_tr_b16 a[18:19], v14 offset:33280
    s_waitcnt lgkmcnt(10)
    v_mfma_f32_32x32x16_bf16 v[48:63], v[128:131], a[4:7], 0
    ds_read_b64_tr_b16 a[20:21], v17 offset:32768
    ds_read_b64_tr_b16 a[22:23], v17 offset:33280
    ds_read_b128 a[40:43], v23 offset:38976
    s_add_u32 m0, s7, 22528
    s_nop 0
    buffer_load_dwordx4 v9, s[12:15], s75 offen offset:0 lds
    s_waitcnt lgkmcnt(12)
    v_mfma_f32_16x16x32_bf16 v[96:99], v[128:131], a[32:35], 0
    s_waitcnt lgkmcnt(9)
    v_mfma_f32_32x32x16_bf16 v[32:47], v[132:135], a[8:11], v[32:47]
    ds_read_b128 v[140:143], v8 offset:0
    ds_read_b64_tr_b16 a[24:25], v15 offset:8192
    ds_read_b64_tr_b16 a[26:27], v15 offset:8704
    buffer_load_dwordx4 v10, s[12:15], s75 offen offset:1024 lds
    s_waitcnt lgkmcnt(10)
    v_mfma_f32_32x32x16_bf16 v[48:63], v[132:135], a[12:15], v[48:63]
    ds_read_b64_tr_b16 a[28:29], v18 offset:8192
    ds_read_b64_tr_b16 a[30:31], v18 offset:8704
    ds_read_b128 a[44:47], v23 offset:39008
    s_add_u32 m0, s7, 12288
    s_nop 0
    buffer_load_dwordx4 v1, s[8:11], s67 offen offset:0 lds
    s_waitcnt lgkmcnt(12)
    v_mfma_f32_16x16x32_bf16 v[96:99], v[132:135], a[36:39], v[96:99]
    s_waitcnt lgkmcnt(9)
    v_mfma_f32_32x32x16_bf16 v[32:47], v[136:139], a[16:19], v[32:47]
    s_waitcnt vmcnt(9)
    s_barrier
    ds_read_b128 v[144:147], v5 offset:4096
    ds_read_b64_tr_b16 a[0:1], v13 offset:18432
    ds_read_b64_tr_b16 a[2:3], v13 offset:18944
    s_waitcnt lgkmcnt(10)
    v_mfma_f32_32x32x16_bf16 v[48:63], v[136:139], a[20:23], v[48:63]
    ds_read_b64_tr_b16 a[4:5], v16 offset:18432
    ds_read_b64_tr_b16 a[6:7], v16 offset:18944
    ds_read_b128 a[32:35], v23 offset:39040
    buffer_load_dwordx4 v2, s[8:11], s67 offen offset:1024 lds
    s_waitcnt lgkmcnt(12)
    v_mfma_f32_16x16x32_bf16 v[96:99], v[136:139], a[40:43], v[96:99]
    s_waitcnt lgkmcnt(9)
    v_mfma_f32_32x32x16_bf16 v[32:47], v[140:143], a[24:27], v[32:47]
    ds_read_b128 v[148:151], v6 offset:4096
    ds_read_b64_tr_b16 a[8:9], v13 offset:59392
    ds_read_b64_tr_b16 a[10:11], v13 offset:59904
    buffer_load_dwordx4 v3, s[8:11], s67 offen offset:2048 lds
    s_waitcnt lgkmcnt(10)
    v_mfma_f32_32x32x16_bf16 v[48:63], v[140:143], a[28:31], v[48:63]
    ds_read_b64_tr_b16 a[12:13], v16 offset:59392
    ds_read_b64_tr_b16 a[14:15], v16 offset:59904
    ds_read_b128 a[36:39], v23 offset:39072
    buffer_load_dwordx4 v4, s[8:11], s67 offen offset:3072 lds
    s_waitcnt lgkmcnt(12)
    v_mfma_f32_16x16x32_bf16 v[96:99], v[140:143], a[44:47], v[96:99]
    v_dot2c_f32_bf16 v26, v128, v128
    v_dot2c_f32_bf16 v26, v129, v129
    v_dot2c_f32_bf16 v26, v130, v130
    v_dot2c_f32_bf16 v26, v131, v131
    v_dot2c_f32_bf16 v26, v132, v132
    v_dot2c_f32_bf16 v26, v133, v133
    v_dot2c_f32_bf16 v26, v134, v134
    v_dot2c_f32_bf16 v26, v135, v135
    v_dot2c_f32_bf16 v26, v136, v136
    v_dot2c_f32_bf16 v26, v137, v137
    v_dot2c_f32_bf16 v26, v138, v138
    v_dot2c_f32_bf16 v26, v139, v139
    v_dot2c_f32_bf16 v26, v140, v140
    v_dot2c_f32_bf16 v26, v141, v141
    v_dot2c_f32_bf16 v26, v142, v142
    v_dot2c_f32_bf16 v26, v143, v143
    s_waitcnt lgkmcnt(9)
    v_mfma_f32_32x32x16_bf16 v[32:47], v[144:147], a[0:3], v[32:47]
    ds_read_b128 v[152:155], v7 offset:4096
    ds_read_b64_tr_b16 a[16:17], v14 offset:34816
    ds_read_b64_tr_b16 a[18:19], v14 offset:35328
    s_add_u32 m0, s7, 24576
    s_nop 0
    buffer_load_dwordx4 v9, s[12:15], s76 offen offset:0 lds
    s_waitcnt lgkmcnt(10)
    v_mfma_f32_32x32x16_bf16 v[48:63], v[144:147], a[4:7], v[48:63]
    ds_read_b64_tr_b16 a[20:21], v17 offset:34816
    ds_read_b64_tr_b16 a[22:23], v17 offset:35328
    ds_read_b128 a[40:43], v23 offset:39104
    buffer_load_dwordx4 v10, s[12:15], s76 offen offset:1024 lds
    s_waitcnt lgkmcnt(12)
    v_mfma_f32_16x16x32_bf16 v[96:99], v[144:147], a[32:35], v[96:99]
    s_waitcnt lgkmcnt(9)
    v_mfma_f32_32x32x16_bf16 v[32:47], v[148:151], a[8:11], v[32:47]
    ds_read_b128 v[156:159], v8 offset:4096
    ds_read_b64_tr_b16 a[24:25], v15 offset:10240
    ds_read_b64_tr_b16 a[26:27], v15 offset:10752
    s_add_u32 m0, s7, 0
    s_nop 0
    buffer_load_dwordx4 v1, s[8:11], s68 offen offset:0 lds
    s_waitcnt lgkmcnt(10)
    v_mfma_f32_32x32x16_bf16 v[48:63], v[148:151], a[12:15], v[48:63]
    ds_read_b64_tr_b16 a[28:29], v18 offset:10240
    ds_read_b64_tr_b16 a[30:31], v18 offset:10752
    ds_read_b128 a[44:47], v23 offset:39136
    buffer_load_dwordx4 v2, s[8:11], s68 offen offset:1024 lds
    s_waitcnt lgkmcnt(12)
    v_mfma_f32_16x16x32_bf16 v[96:99], v[148:151], a[36:39], v[96:99]
    s_waitcnt lgkmcnt(9)
    v_mfma_f32_32x32x16_bf16 v[32:47], v[152:155], a[16:19], v[32:47]
    s_waitcnt vmcnt(10)
    s_barrier
    ds_read_b128 v[160:163], v5 offset:8192
    ds_read_b64_tr_b16 a[0:1], v13 offset:20480
    ds_read_b64_tr_b16 a[2:3], v13 offset:20992
    s_waitcnt lgkmcnt(10)
    v_mfma_f32_32x32x16_bf16 v[48:63], v[152:155], a[20:23], v[48:63]
    ds_read_b64_tr_b16 a[4:5], v16 offset:20480
    ds_read_b64_tr_b16 a[6:7], v16 offset:20992
    ds_read_b128 a[32:35], v23 offset:39168
    buffer_load_dwordx4 v3, s[8:11], s68 offen offset:2048 lds
    s_waitcnt lgkmcnt(12)
    v_mfma_f32_16x16x32_bf16 v[96:99], v[152:155], a[40:43], v[96:99]
    s_waitcnt lgkmcnt(9)
    v_mfma_f32_32x32x16_bf16 v[32:47], v[156:159], a[24:27], v[32:47]
    ds_read_b128 v[164:167], v6 offset:8192
    ds_read_b64_tr_b16 a[8:9], v13 offset:61440
    ds_read_b64_tr_b16 a[10:11], v13 offset:61952
    buffer_load_dwordx4 v4, s[8:11], s68 offen offset:3072 lds
    s_waitcnt lgkmcnt(10)
    v_mfma_f32_32x32x16_bf16 v[48:63], v[156:159], a[28:31], v[48:63]
    ds_read_b64_tr_b16 a[12:13], v16 offset:61440
    ds_read_b64_tr_b16 a[14:15], v16 offset:61952
    ds_read_b128 a[36:39], v23 offset:39200
    s_add_u32 m0, s7, 26624
    s_nop 0
    buffer_load_dwordx4 v9, s[12:15], s77 offen offset:0 lds
    s_waitcnt lgkmcnt(12)
    v_mfma_f32_16x16x32_bf16 v[96:99], v[156:159], a[44:47], v[96:99]
    v_dot2c_f32_bf16 v26, v144, v144
    v_dot2c_f32_bf16 v26, v145, v145
    v_dot2c_f32_bf16 v26, v146, v146
    v_dot2c_f32_bf16 v26, v147, v147
    v_dot2c_f32_bf16 v26, v148, v148
    v_dot2c_f32_bf16 v26, v149, v149
    v_dot2c_f32_bf16 v26, v150, v150
    v_dot2c_f32_bf16 v26, v151, v151
    v_dot2c_f32_bf16 v26, v152, v152
    v_dot2c_f32_bf16 v26, v153, v153
    v_dot2c_f32_bf16 v26, v154, v154
    v_dot2c_f32_bf16 v26, v155, v155
    v_dot2c_f32_bf16 v26, v156, v156
    v_dot2c_f32_bf16 v26, v157, v157
    v_dot2c_f32_bf16 v26, v158, v158
    v_dot2c_f32_bf16 v26, v159, v159
    s_waitcnt lgkmcnt(9)
    v_mfma_f32_32x32x16_bf16 v[32:47], v[160:163], a[0:3], v[32:47]
    ds_read_b128 v[168:171], v7 offset:8192
    ds_read_b64_tr_b16 a[16:17], v14 offset:36864
    ds_read_b64_tr_b16 a[18:19], v14 offset:37376
    buffer_load_dwordx4 v10, s[12:15], s77 offen offset:1024 lds
    s_waitcnt lgkmcnt(10)
    v_mfma_f32_32x32x16_bf16 v[48:63], v[160:163], a[4:7], v[48:63]
    ds_read_b64_tr_b16 a[20:21], v17 offset:36864
    ds_read_b64_tr_b16 a[22:23], v17 offset:37376
    ds_read_b128 a[40:43], v23 offset:39232
    s_add_u32 m0, s7, 4096
    s_nop 0
    buffer_load_dwordx4 v1, s[8:11], s69 offen offset:0 lds
    s_waitcnt lgkmcnt(12)
    v_mfma_f32_16x16x32_bf16 v[96:99], v[160:163], a[32:35], v[96:99]
    s_waitcnt lgkmcnt(9)
    v_mfma_f32_32x32x16_bf16 v[32:47], v[164:167], a[8:11], v[32:47]
    ds_read_b128 v[172:175], v8 offset:8192
    ds_read_b64_tr_b16 a[24:25], v15 offset:12288
    ds_read_b64_tr_b16 a[26:27], v15 offset:12800
    buffer_load_dwordx4 v2, s[8:11], s69 offen offset:1024 lds
    s_waitcnt lgkmcnt(10)
    v_mfma_f32_32x32x16_bf16 v[48:63], v[164:167], a[12:15], v[48:63]
    ds_read_b64_tr_b16 a[28:29], v18 offset:12288
    ds_read_b64_tr_b16 a[30:31], v18 offset:12800
    ds_read_b128 a[44:47], v23 offset:39264
    buffer_load_dwordx4 v3, s[8:11], s69 offen offset:2048 lds
    s_waitcnt lgkmcnt(12)
    v_mfma_f32_16x16x32_bf16 v[96:99], v[164:167], a[36:39], v[96:99]
    s_waitcnt lgkmcnt(9)
    v_mfma_f32_32x32x16_bf16 v[32:47], v[168:171], a[16:19], v[32:47]
    s_waitcnt vmcnt(11)
    s_barrier
    ds_read_b128 v[176:179], v5 offset:12288
    ds_read_b64_tr_b16 a[0:1], v13 offset:22528
    ds_read_b64_tr_b16 a[2:3], v13 offset:23040
    s_waitcnt lgkmcnt(10)
    v_mfma_f32_32x32x16_bf16 v[48:63], v[168:171], a[20:23], v[48:63]
    ds_read_b64_tr_b16 a[4:5], v16 offset:22528
    ds_read_b64_tr_b16 a[6:7], v16 offset:23040
    ds_read_b128 a[32:35], v23 offset:39296
    buffer_load_dwordx4 v4, s[8:11], s69 offen offset:3072 lds
    s_waitcnt lgkmcnt(12)
    v_mfma_f32_16x16x32_bf16 v[96:99], v[168:171], a[40:43], v[96:99]
    s_waitcnt lgkmcnt(9)
    v_mfma_f32_32x32x16_bf16 v[32:47], v[172:175], a[24:27], v[32:47]
    ds_read_b128 v[180:183], v6 offset:12288
    ds_read_b64_tr_b16 a[8:9], v13 offset:63488
    ds_read_b64_tr_b16 a[10:11], v13 offset:64000
    s_add_u32 m0, s7, 28672
    s_nop 0
    buffer_load_dwordx4 v9, s[12:15], s78 offen offset:0 lds
    s_waitcnt lgkmcnt(10)
    v_mfma_f32_32x32x16_bf16 v[48:63], v[172:175], a[28:31], v[48:63]
    ds_read_b64_tr_b16 a[12:13], v16 offset:63488
    ds_read_b64_tr_b16 a[14:15], v16 offset:64000
    ds_read_b128 a[36:39], v23 offset:39328
    buffer_load_dwordx4 v10, s[12:15], s78 offen offset:1024 lds
    s_waitcnt lgkmcnt(12)
    v_mfma_f32_16x16x32_bf16 v[96:99], v[172:175], a[44:47], v[96:99]
    v_dot2c_f32_bf16 v26, v160, v160
    v_dot2c_f32_bf16 v26, v161, v161
    v_dot2c_f32_bf16 v26, v162, v162
    v_dot2c_f32_bf16 v26, v163, v163
    v_dot2c_f32_bf16 v26, v164, v164
    v_dot2c_f32_bf16 v26, v165, v165
    v_dot2c_f32_bf16 v26, v166, v166
    v_dot2c_f32_bf16 v26, v167, v167
    v_dot2c_f32_bf16 v26, v168, v168
    v_dot2c_f32_bf16 v26, v169, v169
    v_dot2c_f32_bf16 v26, v170, v170
    v_dot2c_f32_bf16 v26, v171, v171
    v_dot2c_f32_bf16 v26, v172, v172
    v_dot2c_f32_bf16 v26, v173, v173
    v_dot2c_f32_bf16 v26, v174, v174
    v_dot2c_f32_bf16 v26, v175, v175
    s_waitcnt lgkmcnt(9)
    v_mfma_f32_32x32x16_bf16 v[32:47], v[176:179], a[0:3], v[32:47]
    ds_read_b128 v[184:187], v7 offset:12288
    ds_read_b64_tr_b16 a[16:17], v14 offset:38912
    ds_read_b64_tr_b16 a[18:19], v14 offset:39424
    s_add_u32 m0, s7, 8192
    s_nop 0
    buffer_load_dwordx4 v1, s[8:11], s70 offen offset:0 lds
    s_waitcnt lgkmcnt(10)
    v_mfma_f32_32x32x16_bf16 v[48:63], v[176:179], a[4:7], v[48:63]
    ds_read_b64_tr_b16 a[20:21], v17 offset:38912
    ds_read_b64_tr_b16 a[22:23], v17 offset:39424
    ds_read_b128 a[40:43], v23 offset:39360
    buffer_load_dwordx4 v2, s[8:11], s70 offen offset:1024 lds
    s_waitcnt lgkmcnt(12)
    v_mfma_f32_16x16x32_bf16 v[96:99], v[176:179], a[32:35], v[96:99]
    s_waitcnt lgkmcnt(9)
    v_mfma_f32_32x32x16_bf16 v[32:47], v[180:183], a[8:11], v[32:47]
    ds_read_b128 v[188:191], v8 offset:12288
    ds_read_b64_tr_b16 a[24:25], v15 offset:14336
    ds_read_b64_tr_b16 a[26:27], v15 offset:14848
    buffer_load_dwordx4 v3, s[8:11], s70 offen offset:2048 lds
    s_waitcnt lgkmcnt(10)
    v_mfma_f32_32x32x16_bf16 v[48:63], v[180:183], a[12:15], v[48:63]
    ds_read_b64_tr_b16 a[28:29], v18 offset:14336
    ds_read_b64_tr_b16 a[30:31], v18 offset:14848
    ds_read_b128 a[44:47], v23 offset:39392
    buffer_load_dwordx4 v4, s[8:11], s70 offen offset:3072 lds
    s_waitcnt lgkmcnt(12)
    v_mfma_f32_16x16x32_bf16 v[96:99], v[180:183], a[36:39], v[96:99]
    s_waitcnt lgkmcnt(9)
    v_mfma_f32_32x32x16_bf16 v[32:47], v[184:187], a[16:19], v[32:47]
    s_waitcnt vmcnt(12)
    s_barrier
    ds_read_b128 v[192:195], v5 offset:0
    ds_read_b64_tr_b16 a[0:1], v13 offset:24576
    ds_read_b64_tr_b16 a[2:3], v13 offset:25088
    s_waitcnt lgkmcnt(10)
    v_mfma_f32_32x32x16_bf16 v[48:63], v[184:187], a[20:23], v[48:63]
    ds_read_b64_tr_b16 a[4:5], v16 offset:24576
    ds_read_b64_tr_b16 a[6:7], v16 offset:25088
    ds_read_b128 a[32:35], v23 offset:39424
    s_add_u32 m0, s7, 30720
    s_nop 0
    buffer_load_dwordx4 v9, s[12:15], s79 offen offset:0 lds
    s_waitcnt lgkmcnt(12)
    v_mfma_f32_16x16x32_bf16 v[96:99], v[184:187], a[40:43], v[96:99]
    s_waitcnt lgkmcnt(9)
    v_mfma_f32_32x32x16_bf16 v[32:47], v[188:191], a[24:27], v[32:47]
    ds_read_b128 v[196:199], v6 offset:0
    ds_read_b64_tr_b16 a[8:9], v14 offset:0
    ds_read_b64_tr_b16 a[10:11], v14 offset:512
    buffer_load_dwordx4 v10, s[12:15], s79 offen offset:1024 lds
    s_waitcnt lgkmcnt(10)
    v_mfma_f32_32x32x16_bf16 v[48:63], v[188:191], a[28:31], v[48:63]
    ds_read_b64_tr_b16 a[12:13], v17 offset:0
    ds_read_b64_tr_b16 a[14:15], v17 offset:512
    ds_read_b128 a[36:39], v23 offset:39456
    s_add_u32 m0, s7, 12288
    s_nop 0
    buffer_load_dwordx4 v1, s[8:11], s71 offen offset:0 lds
    s_waitcnt lgkmcnt(12)
    v_mfma_f32_16x16x32_bf16 v[96:99], v[188:191], a[44:47], v[96:99]
    v_dot2c_f32_bf16 v26, v176, v176
    v_dot2c_f32_bf16 v26, v177, v177
    v_dot2c_f32_bf16 v26, v178, v178
    v_dot2c_f32_bf16 v26, v179, v179
    v_dot2c_f32_bf16 v26, v180, v180
    v_dot2c_f32_bf16 v26, v181, v181
    v_dot2c_f32_bf16 v26, v182, v182
    v_dot2c_f32_bf16 v26, v183, v183
    v_dot2c_f32_bf16 v26, v184, v184
    v_dot2c_f32_bf16 v26, v185, v185
    v_dot2c_f32_bf16 v26, v186, v186
    v_dot2c_f32_bf16 v26, v187, v187
    v_dot2c_f32_bf16 v26, v188, v188
    v_dot2c_f32_bf16 v26, v189, v189
    v_dot2c_f32_bf16 v26, v190, v190
    v_dot2c_f32_bf16 v26, v191, v191
    s_waitcnt lgkmcnt(9)
    v_mfma_f32_32x32x16_bf16 v[32:47], v[192:195], a[0:3], v[32:47]
    ds_read_b128 v[200:203], v7 offset:0
    ds_read_b64_tr_b16 a[16:17], v14 offset:40960
    ds_read_b64_tr_b16 a[18:19], v14 offset:41472
    buffer_load_dwordx4 v2, s[8:11], s71 offen offset:1024 lds
    s_waitcnt lgkmcnt(10)
    v_mfma_f32_32x32x16_bf16 v[48:63], v[192:195], a[4:7], v[48:63]
    ds_read_b64_tr_b16 a[20:21], v17 offset:40960
    ds_read_b64_tr_b16 a[22:23], v17 offset:41472
    ds_read_b128 a[40:43], v23 offset:39488
    buffer_load_dwordx4 v3, s[8:11], s71 offen offset:2048 lds
    s_waitcnt lgkmcnt(12)
    v_mfma_f32_16x16x32_bf16 v[96:99], v[192:195], a[32:35], v[96:99]
    s_waitcnt lgkmcnt(9)
    v_mfma_f32_32x32x16_bf16 v[32:47], v[196:199], a[8:11], v[32:47]
    ds_read_b128 v[204:207], v8 offset:0
    ds_read_b64_tr_b16 a[24:25], v15 offset:16384
    ds_read_b64_tr_b16 a[26:27], v15 offset:16896
    buffer_load_dwordx4 v4, s[8:11], s71 offen offset:3072 lds
    s_waitcnt lgkmcnt(10)
    v_mfma_f32_32x32x16_bf16 v[48:63], v[196:199], a[12:15], v[48:63]
    ds_read_b64_tr_b16 a[28:29], v18 offset:16384
    ds_read_b64_tr_b16 a[30:31], v18 offset:16896
    ds_read_b128 a[44:47], v23 offset:39520
    s_add_u32 m0, s7, 32768
    s_nop 0
    buffer_load_dwordx4 v80, s[16:19], s80 offen offset:0 lds
    s_waitcnt lgkmcnt(12)
    v_mfma_f32_16x16x32_bf16 v[96:99], v[196:199], a[36:39], v[96:99]
    s_waitcnt lgkmcnt(9)
    v_mfma_f32_32x32x16_bf16 v[32:47], v[200:203], a[16:19], v[32:47]
    s_waitcnt vmcnt(13)
    s_barrier
    ds_read_b128 v[208:211], v5 offset:4096
    ds_read_b64_tr_b16 a[0:1], v13 offset:26624
    ds_read_b64_tr_b16 a[2:3], v13 offset:27136
    s_waitcnt lgkmcnt(10)
    v_mfma_f32_32x32x16_bf16 v[48:63], v[200:203], a[20:23], v[48:63]
    ds_read_b64_tr_b16 a[4:5], v16 offset:26624
    ds_read_b64_tr_b16 a[6:7], v16 offset:27136
    ds_read_b128 a[32:35], v23 offset:39552
    buffer_load_dwordx4 v81, s[16:19], s80 offen offset:1024 lds
    s_waitcnt lgkmcnt(12)
    v_mfma_f32_16x16x32_bf16 v[96:99], v[200:203], a[40:43], v[96:99]
    s_waitcnt lgkmcnt(9)
    v_mfma_f32_32x32x16_bf16 v[32:47], v[204:207], a[24:27], v[32:47]
    ds_read_b128 v[212:215], v6 offset:4096
    ds_read_b64_tr_b16 a[8:9], v14 offset:2048
    ds_read_b64_tr_b16 a[10:11], v14 offset:2560
    buffer_load_dwordx4 v82, s[16:19], s80 offen offset:2048 lds
    s_waitcnt lgkmcnt(10)
    v_mfma_f32_32x32x16_bf16 v[48:63], v[204:207], a[28:31], v[48:63]
    ds_read_b64_tr_b16 a[12:13], v17 offset:2048
    ds_read_b64_tr_b16 a[14:15], v17 offset:2560
    ds_read_b128 a[36:39], v23 offset:39584
    s_add_u32 m0, s7, 35840
    s_nop 0
    buffer_load_dwordx4 v80, s[16:19], s81 offen offset:0 lds
    s_waitcnt lgkmcnt(12)
    v_mfma_f32_16x16x32_bf16 v[96:99], v[204:207], a[44:47], v[96:99]
    v_dot2c_f32_bf16 v26, v192, v192
    v_dot2c_f32_bf16 v26, v193, v193
    v_dot2c_f32_bf16 v26, v194, v194
    v_dot2c_f32_bf16 v26, v195, v195
    v_dot2c_f32_bf16 v26, v196, v196
    v_dot2c_f32_bf16 v26, v197, v197
    v_dot2c_f32_bf16 v26, v198, v198
    v_dot2c_f32_bf16 v26, v199, v199
    v_dot2c_f32_bf16 v26, v200, v200
    v_dot2c_f32_bf16 v26, v201, v201
    v_dot2c_f32_bf16 v26, v202, v202
    v_dot2c_f32_bf16 v26, v203, v203
    v_dot2c_f32_bf16 v26, v204, v204
    v_dot2c_f32_bf16 v26, v205, v205
    v_dot2c_f32_bf16 v26, v206, v206
    v_dot2c_f32_bf16 v26, v207, v207
    s_waitcnt lgkmcnt(9)
    v_mfma_f32_32x32x16_bf16 v[32:47], v[208:211], a[0:3], v[32:47]
    ds_read_b128 v[216:219], v7 offset:4096
    ds_read_b64_tr_b16 a[16:17], v14 offset:43008
    ds_read_b64_tr_b16 a[18:19], v14 offset:43520
    buffer_load_dwordx4 v81, s[16:19], s81 offen offset:1024 lds
    s_waitcnt lgkmcnt(10)
    v_mfma_f32_32x32x16_bf16 v[48:63], v[208:211], a[4:7], v[48:63]
    ds_read_b64_tr_b16 a[20:21], v17 offset:43008
    ds_read_b64_tr_b16 a[22:23], v17 offset:43520
    ds_read_b128 a[40:43], v23 offset:39616
    buffer_load_dwordx4 v82, s[16:19], s81 offen offset:2048 lds
    s_waitcnt lgkmcnt(12)
    v_mfma_f32_16x16x32_bf16 v[96:99], v[208:211], a[32:35], v[96:99]
    s_waitcnt lgkmcnt(9)
    v_mfma_f32_32x32x16_bf16 v[32:47], v[212:215], a[8:11], v[32:47]
    ds_read_b128 v[220:223], v8 offset:4096
    ds_read_b64_tr_b16 a[24:25], v15 offset:18432
    ds_read_b64_tr_b16 a[26:27], v15 offset:18944
    buffer_load_dword a249, v12, s[12:15], s72 offen
    s_waitcnt lgkmcnt(10)
    v_mfma_f32_32x32x16_bf16 v[48:63], v[212:215], a[12:15], v[48:63]
    ds_read_b64_tr_b16 a[28:29], v18 offset:18432
    ds_read_b64_tr_b16 a[30:31], v18 offset:18944
    ds_read_b128 a[44:47], v23 offset:39648
    s_add_u32 m0, s7, 40448
    s_nop 0
    buffer_load_dword v88, s[88:91], s63 offen lds
    s_waitcnt lgkmcnt(12)
    v_mfma_f32_16x16x32_bf16 v[96:99], v[212:215], a[36:39], v[96:99]
    s_waitcnt lgkmcnt(9)
    v_mfma_f32_32x32x16_bf16 v[32:47], v[216:219], a[16:19], v[32:47]
    s_waitcnt vmcnt(14)
    s_barrier
    ds_read_b128 v[224:227], v5 offset:8192
    ds_read_b64_tr_b16 a[0:1], v13 offset:28672
    ds_read_b64_tr_b16 a[2:3], v13 offset:29184
    s_waitcnt lgkmcnt(10)
    v_mfma_f32_32x32x16_bf16 v[48:63], v[216:219], a[20:23], v[48:63]
    ds_read_b64_tr_b16 a[4:5], v16 offset:28672
    ds_read_b64_tr_b16 a[6:7], v16 offset:29184
    ds_read_b128 a[32:35], v23 offset:39680
    buffer_load_dwordx2 v[86:87], off, s[48:51], 0 sc1
    s_waitcnt lgkmcnt(12)
    v_mfma_f32_16x16x32_bf16 v[96:99], v[216:219], a[40:43], v[96:99]
    s_waitcnt lgkmcnt(9)
    v_mfma_f32_32x32x16_bf16 v[32:47], v[220:223], a[24:27], v[32:47]
    ds_read_b128 v[228:231], v6 offset:8192
    ds_read_b64_tr_b16 a[8:9], v14 offset:4096
    ds_read_b64_tr_b16 a[10:11], v14 offset:4608
    s_waitcnt lgkmcnt(10)
    v_mfma_f32_32x32x16_bf16 v[48:63], v[220:223], a[28:31], v[48:63]
    ds_read_b64_tr_b16 a[12:13], v17 offset:4096
    ds_read_b64_tr_b16 a[14:15], v17 offset:4608
    ds_read_b128 a[36:39], v23 offset:39712
    s_waitcnt lgkmcnt(12)
    v_mfma_f32_16x16x32_bf16 v[96:99], v[220:223], a[44:47], v[96:99]
    v_dot2c_f32_bf16 v26, v208, v208
    v_dot2c_f32_bf16 v26, v209, v209
    v_dot2c_f32_bf16 v26, v210, v210
    v_dot2c_f32_bf16 v26, v211, v211
    v_dot2c_f32_bf16 v26, v212, v212
    v_dot2c_f32_bf16 v26, v213, v213
    v_dot2c_f32_bf16 v26, v214, v214
    v_dot2c_f32_bf16 v26, v215, v215
    v_dot2c_f32_bf16 v26, v216, v216
    v_dot2c_f32_bf16 v26, v217, v217
    v_dot2c_f32_bf16 v26, v218, v218
    v_dot2c_f32_bf16 v26, v219, v219
    v_dot2c_f32_bf16 v26, v220, v220
    v_dot2c_f32_bf16 v26, v221, v221
    v_dot2c_f32_bf16 v26, v222, v222
    v_dot2c_f32_bf16 v26, v223, v223
    s_waitcnt lgkmcnt(9)
    v_mfma_f32_32x32x16_bf16 v[32:47], v[224:227], a[0:3], v[32:47]
    ds_read_b128 v[232:235], v7 offset:8192
    ds_read_b64_tr_b16 a[16:17], v14 offset:45056
    ds_read_b64_tr_b16 a[18:19], v14 offset:45568
    s_waitcnt lgkmcnt(10)
    v_mfma_f32_32x32x16_bf16 v[48:63], v[224:227], a[4:7], v[48:63]
    ds_read_b64_tr_b16 a[20:21], v17 offset:45056
    ds_read_b64_tr_b16 a[22:23], v17 offset:45568
    ds_read_b128 a[40:43], v23 offset:39744
    s_waitcnt lgkmcnt(12)
    v_mfma_f32_16x16x32_bf16 v[96:99], v[224:227], a[32:35], v[96:99]
    s_waitcnt lgkmcnt(9)
    v_mfma_f32_32x32x16_bf16 v[32:47], v[228:231], a[8:11], v[32:47]
    ds_read_b128 v[236:239], v8 offset:8192
    ds_read_b64_tr_b16 a[24:25], v15 offset:20480
    ds_read_b64_tr_b16 a[26:27], v15 offset:20992
    s_waitcnt lgkmcnt(10)
    v_mfma_f32_32x32x16_bf16 v[48:63], v[228:231], a[12:15], v[48:63]
    ds_read_b64_tr_b16 a[28:29], v18 offset:20480
    ds_read_b64_tr_b16 a[30:31], v18 offset:20992
    ds_read_b128 a[44:47], v23 offset:39776
    s_waitcnt lgkmcnt(12)
    v_mfma_f32_16x16x32_bf16 v[96:99], v[228:231], a[36:39], v[96:99]
    s_waitcnt lgkmcnt(9)
    v_mfma_f32_32x32x16_bf16 v[32:47], v[232:235], a[16:19], v[32:47]
    s_waitcnt vmcnt(9)
    s_barrier
    ds_read_b128 v[240:243], v5 offset:12288
    ds_read_b64_tr_b16 a[0:1], v13 offset:30720
    ds_read_b64_tr_b16 a[2:3], v13 offset:31232
    s_waitcnt lgkmcnt(10)
    v_mfma_f32_32x32x16_bf16 v[48:63], v[232:235], a[20:23], v[48:63]
    ds_read_b64_tr_b16 a[4:5], v16 offset:30720
    ds_read_b64_tr_b16 a[6:7], v16 offset:31232
    ds_read_b128 a[32:35], v23 offset:39808
    s_waitcnt lgkmcnt(12)
    v_mfma_f32_16x16x32_bf16 v[96:99], v[232:235], a[40:43], v[96:99]
    s_waitcnt lgkmcnt(9)
    v_mfma_f32_32x32x16_bf16 v[32:47], v[236:239], a[24:27], v[32:47]
    ds_read_b128 v[244:247], v6 offset:12288
    ds_read_b64_tr_b16 a[8:9], v14 offset:6144
    ds_read_b64_tr_b16 a[10:11], v14 offset:6656
    s_add_u32 m0, s7, 0
    s_nop 0
    buffer_load_dwordx4 v80, s[16:19], s82 offen offset:0 lds
    s_waitcnt lgkmcnt(10)
    v_mfma_f32_32x32x16_bf16 v[48:63], v[236:239], a[28:31], v[48:63]
    ds_read_b64_tr_b16 a[12:13], v17 offset:6144
    ds_read_b64_tr_b16 a[14:15], v17 offset:6656
    ds_read_b128 a[36:39], v23 offset:39840
    buffer_load_dwordx4 v81, s[16:19], s82 offen offset:1024 lds
    s_waitcnt lgkmcnt(12)
    v_mfma_f32_16x16x32_bf16 v[96:99], v[236:239], a[44:47], v[96:99]
    v_dot2c_f32_bf16 v26, v224, v224
    v_dot2c_f32_bf16 v26, v225, v225
    v_dot2c_f32_bf16 v26, v226, v226
    v_dot2c_f32_bf16 v26, v227, v227
    v_dot2c_f32_bf16 v26, v228, v228
    v_dot2c_f32_bf16 v26, v229, v229
    v_dot2c_f32_bf16 v26, v230, v230
    v_dot2c_f32_bf16 v26, v231, v231
    v_dot2c_f32_bf16 v26, v232, v232
    v_dot2c_f32_bf16 v26, v233, v233
    v_dot2c_f32_bf16 v26, v234, v234
    v_dot2c_f32_bf16 v26, v235, v235
    v_dot2c_f32_bf16 v26, v236, v236
    v_dot2c_f32_bf16 v26, v237, v237
    v_dot2c_f32_bf16 v26, v238, v238
    v_dot2c_f32_bf16 v26, v239, v239
    s_waitcnt lgkmcnt(9)
    v_mfma_f32_32x32x16_bf16 v[32:47], v[240:243], a[0:3], v[32:47]
    ds_read_b128 v[248:251], v7 offset:12288
    ds_read_b64_tr_b16 a[16:17], v14 offset:47104
    ds_read_b64_tr_b16 a[18:19], v14 offset:47616
    buffer_load_dwordx4 v82, s[16:19], s82 offen offset:2048 lds
    s_waitcnt lgkmcnt(10)
    v_mfma_f32_32x32x16_bf16 v[48:63], v[240:243], a[4:7], v[48:63]
    ds_read_b64_tr_b16 a[20:21], v17 offset:47104
    ds_read_b64_tr_b16 a[22:23], v17 offset:47616
    ds_read_b128 a[40:43], v23 offset:39872
    s_waitcnt lgkmcnt(12)
    v_mfma_f32_16x16x32_bf16 v[96:99], v[240:243], a[32:35], v[96:99]
    s_waitcnt lgkmcnt(9)
    v_mfma_f32_32x32x16_bf16 v[32:47], v[244:247], a[8:11], v[32:47]
    ds_read_b128 v[252:255], v8 offset:12288
    ds_read_b64_tr_b16 a[24:25], v15 offset:22528
    ds_read_b64_tr_b16 a[26:27], v15 offset:23040
    s_waitcnt lgkmcnt(10)
    v_mfma_f32_32x32x16_bf16 v[48:63], v[244:247], a[12:15], v[48:63]
    ds_read_b64_tr_b16 a[28:29], v18 offset:22528
    ds_read_b64_tr_b16 a[30:31], v18 offset:23040
    ds_read_b128 a[44:47], v23 offset:39904
    s_waitcnt lgkmcnt(12)
    v_mfma_f32_16x16x32_bf16 v[96:99], v[244:247], a[36:39], v[96:99]
    s_waitcnt lgkmcnt(9)
    v_mfma_f32_32x32x16_bf16 v[32:47], v[248:251], a[16:19], v[32:47]
    s_waitcnt lgkmcnt(7)
    v_mfma_f32_32x32x16_bf16 v[48:63], v[248:251], a[20:23], v[48:63]
    s_waitcnt lgkmcnt(6)
    v_mfma_f32_16x16x32_bf16 v[96:99], v[248:251], a[40:43], v[96:99]
    s_waitcnt lgkmcnt(3)
    v_mfma_f32_32x32x16_bf16 v[32:47], v[252:255], a[24:27], v[32:47]
    s_waitcnt lgkmcnt(1)
    v_mfma_f32_32x32x16_bf16 v[48:63], v[252:255], a[28:31], v[48:63]
    s_waitcnt lgkmcnt(0)
    v_mfma_f32_16x16x32_bf16 v[96:99], v[252:255], a[44:47], v[96:99]
    s_branch L_kv_done
Lnon_1:
    s_mov_b32 s63, 0
Lnon_1_l:
    s_sleep 2
    buffer_load_dwordx2 v[86:87], off, s[48:51], 0 sc1
    s_waitcnt vmcnt(0)
    v_readfirstlane_b32 s52, v86
    s_add_u32 s63, s63, 1
    s_cmp_lg_u32 s52, 0
    s_cbranch_scc1 Lnonb_2
    s_cmp_lt_u32 s63, 0x40000
    s_cbranch_scc1 Lnon_1_l
    s_branch Lnonb_2
Lpoll_3:
    s_mov_b32 s63, 0
Lpoll_3_l:
    buffer_load_dwordx2 v[8:9], v23, s[28:31], 0 offen sc1
    s_waitcnt vmcnt(0)
    v_cmp_ne_u64 vcc, s[52:53], v[8:9]
    s_add_u32 s63, s63, 1
    s_nop 0
    s_cmp_eq_u64 vcc, 0
    s_cbranch_scc1 Lpollb_4
    s_sleep 1
    s_cmp_lt_u32 s63, 0x40000
    s_cbranch_scc1 Lpoll_3_l
    s_branch Lpollb_4
Lpoll_5:
    s_mov_b32 s63, 0
Lpoll_5_l:
    buffer_load_dwordx2 v[8:9], v13, s[28:31], 0 offen sc1
    s_waitcnt vmcnt(0)
    v_cmp_ne_u64 vcc, s[52:53], v[8:9]
    s_add_u32 s63, s63, 1
    s_nop 0
    s_cmp_eq_u64 vcc, 0
    s_cbranch_scc1 Lpollb_6
    s_sleep 1
    s_cmp_lt_u32 s63, 0x40000
    s_cbranch_scc1 Lpoll_5_l
    s_branch Lpollb_6
L_exact:
    s_waitcnt vmcnt(0) lgkmcnt(0)
    s_nop 15
    s_nop 7
    ds_read_b128 a[0:3], v60 offset:0
    s_waitcnt lgkmcnt(0)
    v_mfma_f32_32x32x16_bf16 v[128:143], a[0:3], v[96:99], 0
    ds_read_b128 a[4:7], v60 offset:8448
    s_waitcnt lgkmcnt(0)
    v_mfma_f32_32x32x16_bf16 v[144:159], a[4:7], v[96:99], 0
    s_nop 11
    v_cndmask_b32 v128, v144, v128, s[64:65]
    v_cndmask_b32 v129, v145, v129, s[66:67]
    v_cndmask_b32 v130, v146, v130, s[68:69]
    v_cndmask_b32 v131, v147, v131, s[70:71]
    v_cndmask_b32 v132, v148, v132, s[72:73]
    v_cndmask_b32 v133, v149, v133, s[74:75]
    v_cndmask_b32 v134, v150, v134, s[76:77]
    v_cndmask_b32 v135, v151, v135, s[78:79]
    v_cndmask_b32 v136, v152, v136, s[80:81]
    v_cndmask_b32 v137, v153, v137, s[82:83]
    v_cndmask_b32 v138, v154, v138, s[84:85]
    v_cndmask_b32 v139, v155, v139, s[86:87]
    v_cndmask_b32 v140, v156, v140, s[88:89]
    v_cndmask_b32 v141, v157, v141, s[90:91]
    v_cndmask_b32 v142, v158, v142, s[92:93]
    v_cndmask_b32 v143, v159, v143, s[94:95]
    v_mov_b32 v64, v128
    v_max3_f32 v64, v64, v128, v129
    v_max3_f32 v64, v64, v130, v131
    v_max3_f32 v64, v64, v132, v133
    v_max3_f32 v64, v64, v134, v135
    v_max3_f32 v64, v64, v136, v137
    v_max3_f32 v64, v64, v138, v139
    v_max3_f32 v64, v64, v140, v141
    v_max3_f32 v64, v64, v142, v143
    ds_read_b128 a[0:3], v61 offset:0
    s_waitcnt lgkmcnt(0)
    v_mfma_f32_32x32x16_bf16 v[128:143], a[0:3], v[96:99], 0
    s_nop 11
    v_max3_f32 v64, v64, v128, v129
    v_max3_f32 v64, v64, v130, v131
    v_max3_f32 v64, v64, v132, v133
    v_max3_f32 v64, v64, v134, v135
    v_max3_f32 v64, v64, v136, v137
    v_max3_f32 v64, v64, v138, v139
    v_max3_f32 v64, v64, v140, v141
    v_max3_f32 v64, v64, v142, v143
    ds_read_b128 a[0:3], v62 offset:0
    s_waitcnt lgkmcnt(0)
    v_mfma_f32_32x32x16_bf16 v[128:143], a[0:3], v[96:99], 0
    s_nop 11
    v_max3_f32 v64, v64, v128, v129
    v_max3_f32 v64, v64, v130, v131
    v_max3_f32 v64, v64, v132, v133
    v_max3_f32 v64, v64, v134, v135
    v_max3_f32 v64, v64, v136, v137
    v_max3_f32 v64, v64, v138, v139
    v_max3_f32 v64, v64, v140, v141
    v_max3_f32 v64, v64, v142, v143
    ds_read_b128 a[0:3], v63 offset:0
    s_waitcnt lgkmcnt(0)
    v_mfma_f32_32x32x16_bf16 v[128:143], a[0:3], v[96:99], 0
    s_nop 11
    v_max3_f32 v64, v64, v128, v129
    v_max3_f32 v64, v64, v130, v131
    v_max3_f32 v64, v64, v132, v133
    v_max3_f32 v64, v64, v134, v135
    v_max3_f32 v64, v64, v136, v137
    v_max3_f32 v64, v64, v138, v139
    v_max3_f32 v64, v64, v140, v141
    v_max3_f32 v64, v64, v142, v143
    ds_read_b128 a[0:3], v60 offset:4224
    s_waitcnt lgkmcnt(0)
    v_mfma_f32_32x32x16_bf16 v[128:143], a[0:3], v[96:99], 0
    s_nop 11
    v_max3_f32 v64, v64, v128, v129
    v_max3_f32 v64, v64, v130, v131
    v_max3_f32 v64, v64, v132, v133
    v_max3_f32 v64, v64, v134, v135
    v_max3_f32 v64, v64, v136, v137
    v_max3_f32 v64, v64, v138, v139
    v_max3_f32 v64, v64, v140, v141
    v_max3_f32 v64, v64, v142, v143
    ds_read_b128 a[0:3], v61 offset:4224
    s_waitcnt lgkmcnt(0)
    v_mfma_f32_32x32x16_bf16 v[128:143], a[0:3], v[96:99], 0
    s_nop 11
    v_max3_f32 v64, v64, v128, v129
    v_max3_f32 v64, v64, v130, v131
    v_max3_f32 v64, v64, v132, v133
    v_max3_f32 v64, v64, v134, v135
    v_max3_f32 v64, v64, v136, v137
    v_max3_f32 v64, v64, v138, v139
    v_max3_f32 v64, v64, v140, v141
    v_max3_f32 v64, v64, v142, v143
    ds_read_b128 a[0:3], v62 offset:4224
    s_waitcnt lgkmcnt(0)
    v_mfma_f32_32x32x16_bf16 v[128:143], a[0:3], v[96:99], 0
    s_nop 11
    v_max3_f32 v64, v64, v128, v129
    v_max3_f32 v64, v64, v130, v131
    v_max3_f32 v64, v64, v132, v133
    v_max3_f32 v64, v64, v134, v135
    v_max3_f32 v64, v64, v136, v137
    v_max3_f32 v64, v64, v138, v139
    v_max3_f32 v64, v64, v140, v141
    v_max3_f32 v64, v64, v142, v143
    ds_read_b128 a[0:3], v63 offset:4224
    s_waitcnt lgkmcnt(0)
    v_mfma_f32_32x32x16_bf16 v[128:143], a[0:3], v[96:99], 0
    s_nop 11
    v_max3_f32 v64, v64, v128, v129
    v_max3_f32 v64, v64, v130, v131
    v_max3_f32 v64, v64, v132, v133
    v_max3_f32 v64, v64, v134, v135
    v_max3_f32 v64, v64, v136, v137
    v_max3_f32 v64, v64, v138, v139
    v_max3_f32 v64, v64, v140, v141
    v_max3_f32 v64, v64, v142, v143
    v_mov_b32 v65, v64
    s_nop 1
    v_permlane32_swap_b32 v65, v64
    v_max_f32 v64, v64, v65
    v_sub_f32 v160, 0, v64
    v_sub_f32 v161, 0, v64
    v_sub_f32 v162, 0, v64
    v_sub_f32 v163, 0, v64
    v_sub_f32 v164, 0, v64
    v_sub_f32 v165, 0, v64
    v_sub_f32 v166, 0, v64
    v_sub_f32 v167, 0, v64
    v_sub_f32 v168, 0, v64
    v_sub_f32 v169, 0, v64
    v_sub_f32 v170, 0, v64
    v_sub_f32 v171, 0, v64
    v_sub_f32 v172, 0, v64
    v_sub_f32 v173, 0, v64
    v_sub_f32 v174, 0, v64
    v_sub_f32 v175, 0, v64
    ds_read_b128 a[0:3], v60 offset:0
    s_waitcnt lgkmcnt(0)
    v_mfma_f32_32x32x16_bf16 v[128:143], a[0:3], v[96:99], v[160:175]
    ds_read_b128 a[4:7], v60 offset:8448
    s_waitcnt lgkmcnt(0)
    v_mfma_f32_32x32x16_bf16 v[144:159], a[4:7], v[96:99], v[160:175]
    s_nop 11
    v_cndmask_b32 v128, v144, v128, s[64:65]
    v_cndmask_b32 v129, v145, v129, s[66:67]
    v_cndmask_b32 v130, v146, v130, s[68:69]
    v_cndmask_b32 v131, v147, v131, s[70:71]
    v_cndmask_b32 v132, v148, v132, s[72:73]
    v_cndmask_b32 v133, v149, v133, s[74:75]
    v_cndmask_b32 v134, v150, v134, s[76:77]
    v_cndmask_b32 v135, v151, v135, s[78:79]
    v_cndmask_b32 v136, v152, v136, s[80:81]
    v_cndmask_b32 v137, v153, v137, s[82:83]
    v_cndmask_b32 v138, v154, v138, s[84:85]
    v_cndmask_b32 v139, v155, v139, s[86:87]
    v_cndmask_b32 v140, v156, v140, s[88:89]
    v_cndmask_b32 v141, v157, v141, s[90:91]
    v_cndmask_b32 v142, v158, v142, s[92:93]
    v_cndmask_b32 v143, v159, v143, s[94:95]
    ds_read_b128 a[72:75], v112 offset:2112
    ds_read_b128 a[76:79], v112 offset:3168
    ds_read_b128 a[80:83], v112 offset:10560
    ds_read_b128 a[84:87], v112 offset:11616
    v_exp_f32 v128, v128
    v_exp_f32 v129, v129
    v_exp_f32 v130, v130
    v_exp_f32 v131, v131
    v_exp_f32 v132, v132
    v_exp_f32 v133, v133
    v_exp_f32 v134, v134
    v_exp_f32 v135, v135
    v_exp_f32 v136, v136
    v_exp_f32 v137, v137
    v_exp_f32 v138, v138
    v_exp_f32 v139, v139
    v_exp_f32 v140, v140
    v_exp_f32 v141, v141
    v_exp_f32 v142, v142
    v_exp_f32_e64 v143, v143
    v_cvt_pk_bf16_f32 v32, v128, v129
    v_cvt_pk_bf16_f32 v33, v130, v131
    v_cvt_pk_bf16_f32 v34, v132, v133
    v_cvt_pk_bf16_f32 v35, v134, v135
    v_cvt_pk_bf16_f32 v36, v136, v137
    v_cvt_pk_bf16_f32 v37, v138, v139
    v_cvt_pk_bf16_f32 v38, v140, v141
    v_cvt_pk_bf16_f32 v39, v142, v143
    v_and_b32 v40, v32, v104
    v_and_b32 v41, v33, v105
    v_and_b32 v42, v34, v106
    v_and_b32 v43, v35, v107
    v_and_b32 v44, v36, v108
    v_and_b32 v45, v37, v109
    v_and_b32 v46, v38, v110
    v_and_b32 v47, v39, v111
    v_xor_b32 v32, v32, v40
    v_xor_b32 v33, v33, v41
    v_xor_b32 v34, v34, v42
    v_xor_b32 v35, v35, v43
    v_xor_b32 v36, v36, v44
    v_xor_b32 v37, v37, v45
    v_xor_b32 v38, v38, v46
    v_xor_b32_e64 v39, v39, v47
    s_waitcnt lgkmcnt(1)
    v_mfma_f32_32x32x16_bf16 v[176:191], a[80:83], v[32:35], 0
    s_waitcnt lgkmcnt(0)
    v_mfma_f32_32x32x16_bf16 v[176:191], a[84:87], v[36:39], v[176:191]
    v_mfma_f32_32x32x16_bf16 v[176:191], a[72:75], v[40:43], v[176:191]
    v_mfma_f32_32x32x16_bf16 v[176:191], a[76:79], v[44:47], v[176:191]
    s_nop 15
    ds_read_b128 a[0:3], v61 offset:0
    s_waitcnt lgkmcnt(0)
    v_mfma_f32_32x32x16_bf16 v[128:143], a[0:3], v[96:99], v[160:175]
    ds_read_b128 a[72:75], v113 offset:2112
    ds_read_b128 a[76:79], v113 offset:3168
    s_nop 9
    v_exp_f32 v128, v128
    v_exp_f32 v129, v129
    v_exp_f32 v130, v130
    v_exp_f32 v131, v131
    v_exp_f32 v132, v132
    v_exp_f32 v133, v133
    v_exp_f32 v134, v134
    v_exp_f32 v135, v135
    v_exp_f32 v136, v136
    v_exp_f32 v137, v137
    v_exp_f32 v138, v138
    v_exp_f32 v139, v139
    v_exp_f32 v140, v140
    v_exp_f32 v141, v141
    v_exp_f32 v142, v142
    v_exp_f32 v143, v143
    v_cvt_pk_bf16_f32 v32, v128, v129
    v_cvt_pk_bf16_f32 v33, v130, v131
    v_cvt_pk_bf16_f32 v34, v132, v133
    v_cvt_pk_bf16_f32 v35, v134, v135
    v_cvt_pk_bf16_f32 v36, v136, v137
    v_cvt_pk_bf16_f32 v37, v138, v139
    v_cvt_pk_bf16_f32 v38, v140, v141
    v_cvt_pk_bf16_f32 v39, v142, v143
    s_waitcnt lgkmcnt(1)
    v_mfma_f32_32x32x16_bf16 v[176:191], a[72:75], v[32:35], v[176:191]
    s_waitcnt lgkmcnt(0)
    v_mfma_f32_32x32x16_bf16 v[176:191], a[76:79], v[36:39], v[176:191]
    s_nop 15
    ds_read_b128 a[0:3], v62 offset:0
    s_waitcnt lgkmcnt(0)
    v_mfma_f32_32x32x16_bf16 v[128:143], a[0:3], v[96:99], v[160:175]
    ds_read_b128 a[72:75], v114 offset:2112
    ds_read_b128 a[76:79], v114 offset:3168
    s_nop 9
    v_exp_f32 v128, v128
    v_exp_f32 v129, v129
    v_exp_f32 v130, v130
    v_exp_f32 v131, v131
    v_exp_f32 v132, v132
    v_exp_f32 v133, v133
    v_exp_f32 v134, v134
    v_exp_f32 v135, v135
    v_exp_f32 v136, v136
    v_exp_f32 v137, v137
    v_exp_f32 v138, v138
    v_exp_f32 v139, v139
    v_exp_f32 v140, v140
    v_exp_f32 v141, v141
    v_exp_f32 v142, v142
    v_exp_f32_e64 v143, v143
    v_cvt_pk_bf16_f32 v32, v128, v129
    v_cvt_pk_bf16_f32 v33, v130, v131
    v_cvt_pk_bf16_f32 v34, v132, v133
    v_cvt_pk_bf16_f32 v35, v134, v135
    v_cvt_pk_bf16_f32 v36, v136, v137
    v_cvt_pk_bf16_f32 v37, v138, v139
    v_cvt_pk_bf16_f32 v38, v140, v141
    v_cvt_pk_bf16_f32 v39, v142, v143
    s_waitcnt lgkmcnt(1)
    v_mfma_f32_32x32x16_bf16 v[176:191], a[72:75], v[32:35], v[176:191]
    s_waitcnt lgkmcnt(0)
    v_mfma_f32_32x32x16_bf16 v[176:191], a[76:79], v[36:39], v[176:191]
    s_nop 15
    ds_read_b128 a[0:3], v63 offset:0
    s_waitcnt lgkmcnt(0)
    v_mfma_f32_32x32x16_bf16 v[128:143], a[0:3], v[96:99], v[160:175]
    ds_read_b128 a[72:75], v115 offset:2112
    ds_read_b128 a[76:79], v115 offset:3168
    s_nop 9
    v_exp_f32 v128, v128
    v_exp_f32 v129, v129
    v_exp_f32 v130, v130
    v_exp_f32 v131, v131
    v_exp_f32 v132, v132
    v_exp_f32 v133, v133
    v_exp_f32 v134, v134
    v_exp_f32 v135, v135
    v_exp_f32 v136, v136
    v_exp_f32 v137, v137
    v_exp_f32 v138, v138
    v_exp_f32 v139, v139
    v_exp_f32 v140, v140
    v_exp_f32 v141, v141
    v_exp_f32 v142, v142
    v_exp_f32_e64 v143, v143
    v_cvt_pk_bf16_f32 v32, v128, v129
    v_cvt_pk_bf16_f32 v33, v130, v131
    v_cvt_pk_bf16_f32 v34, v132, v133
    v_cvt_pk_bf16_f32 v35, v134, v135
    v_cvt_pk_bf16_f32 v36, v136, v137
    v_cvt_pk_bf16_f32 v37, v138, v139
    v_cvt_pk_bf16_f32 v38, v140, v141
    v_cvt_pk_bf16_f32 v39, v142, v143
    s_waitcnt lgkmcnt(1)
    v_mfma_f32_32x32x16_bf16 v[176:191], a[72:75], v[32:35], v[176:191]
    s_waitcnt lgkmcnt(0)
    v_mfma_f32_32x32x16_bf16 v[176:191], a[76:79], v[36:39], v[176:191]
    s_nop 15
    ds_read_b128 a[0:3], v60 offset:4224
    s_waitcnt lgkmcnt(0)
    v_mfma_f32_32x32x16_bf16 v[128:143], a[0:3], v[96:99], v[160:175]
    ds_read_b128 a[72:75], v112 offset:6336
    ds_read_b128 a[76:79], v112 offset:7392
    s_nop 9
    v_exp_f32 v128, v128
    v_exp_f32 v129, v129
    v_exp_f32 v130, v130
    v_exp_f32 v131, v131
    v_exp_f32 v132, v132
    v_exp_f32 v133, v133
    v_exp_f32 v134, v134
    v_exp_f32 v135, v135
    v_exp_f32 v136, v136
    v_exp_f32 v137, v137
    v_exp_f32 v138, v138
    v_exp_f32 v139, v139
    v_exp_f32 v140, v140
    v_exp_f32 v141, v141
    v_exp_f32 v142, v142
    v_exp_f32_e64 v143, v143
    v_cvt_pk_bf16_f32 v32, v128, v129
    v_cvt_pk_bf16_f32 v33, v130, v131
    v_cvt_pk_bf16_f32 v34, v132, v133
    v_cvt_pk_bf16_f32 v35, v134, v135
    v_cvt_pk_bf16_f32 v36, v136, v137
    v_cvt_pk_bf16_f32 v37, v138, v139
    v_cvt_pk_bf16_f32 v38, v140, v141
    v_cvt_pk_bf16_f32 v39, v142, v143
    s_waitcnt lgkmcnt(1)
    v_mfma_f32_32x32x16_bf16 v[176:191], a[72:75], v[32:35], v[176:191]
    s_waitcnt lgkmcnt(0)
    v_mfma_f32_32x32x16_bf16 v[176:191], a[76:79], v[36:39], v[176:191]
    s_nop 15
    ds_read_b128 a[0:3], v61 offset:4224
    s_waitcnt lgkmcnt(0)
    v_mfma_f32_32x32x16_bf16 v[128:143], a[0:3], v[96:99], v[160:175]
    ds_read_b128 a[72:75], v113 offset:6336
    ds_read_b128 a[76:79], v113 offset:7392
    s_nop 9
    v_exp_f32 v128, v128
    v_exp_f32 v129, v129
    v_exp_f32 v130, v130
    v_exp_f32 v131, v131
    v_exp_f32 v132, v132
    v_exp_f32 v133, v133
    v_exp_f32 v134, v134
    v_exp_f32 v135, v135
    v_exp_f32 v136, v136
    v_exp_f32 v137, v137
    v_exp_f32 v138, v138
    v_exp_f32 v139, v139
    v_exp_f32 v140, v140
    v_exp_f32 v141, v141
    v_exp_f32 v142, v142
    v_exp_f32_e64 v143, v143
    v_cvt_pk_bf16_f32 v32, v128, v129
    v_cvt_pk_bf16_f32 v33, v130, v131
    v_cvt_pk_bf16_f32 v34, v132, v133
    v_cvt_pk_bf16_f32 v35, v134, v135
    v_cvt_pk_bf16_f32 v36, v136, v137
    v_cvt_pk_bf16_f32 v37, v138, v139
    v_cvt_pk_bf16_f32 v38, v140, v141
    v_cvt_pk_bf16_f32 v39, v142, v143
    s_waitcnt lgkmcnt(1)
    v_mfma_f32_32x32x16_bf16 v[176:191], a[72:75], v[32:35], v[176:191]
    s_waitcnt lgkmcnt(0)
    v_mfma_f32_32x32x16_bf16 v[176:191], a[76:79], v[36:39], v[176:191]
    s_nop 15
    ds_read_b128 a[0:3], v62 offset:4224
    s_waitcnt lgkmcnt(0)
    v_mfma_f32_32x32x16_bf16 v[128:143], a[0:3], v[96:99], v[160:175]
    ds_read_b128 a[72:75], v114 offset:6336
    ds_read_b128 a[76:79], v114 offset:7392
    s_nop 9
    v_exp_f32 v128, v128
    v_exp_f32 v129, v129
    v_exp_f32 v130, v130
    v_exp_f32 v131, v131
    v_exp_f32 v132, v132
    v_exp_f32 v133, v133
    v_exp_f32 v134, v134
    v_exp_f32 v135, v135
    v_exp_f32 v136, v136
    v_exp_f32 v137, v137
    v_exp_f32 v138, v138
    v_exp_f32 v139, v139
    v_exp_f32 v140, v140
    v_exp_f32 v141, v141
    v_exp_f32 v142, v142
    v_exp_f32_e64 v143, v143
    v_cvt_pk_bf16_f32 v32, v128, v129
    v_cvt_pk_bf16_f32 v33, v130, v131
    v_cvt_pk_bf16_f32 v34, v132, v133
    v_cvt_pk_bf16_f32 v35, v134, v135
    v_cvt_pk_bf16_f32 v36, v136, v137
    v_cvt_pk_bf16_f32 v37, v138, v139
    v_cvt_pk_bf16_f32 v38, v140, v141
    v_cvt_pk_bf16_f32 v39, v142, v143
    s_waitcnt lgkmcnt(1)
    v_mfma_f32_32x32x16_bf16 v[176:191], a[72:75], v[32:35], v[176:191]
    s_waitcnt lgkmcnt(0)
    v_mfma_f32_32x32x16_bf16 v[176:191], a[76:79], v[36:39], v[176:191]
    s_nop 15
    ds_read_b128 a[0:3], v63 offset:4224
    s_waitcnt lgkmcnt(0)
    v_mfma_f32_32x32x16_bf16 v[128:143], a[0:3], v[96:99], v[160:175]
    ds_read_b128 a[72:75], v115 offset:6336
    ds_read_b128 a[76:79], v115 offset:7392
    s_nop 9
    v_exp_f32 v128, v128
    v_exp_f32 v129, v129
    v_exp_f32 v130, v130
    v_exp_f32 v131, v131
    v_exp_f32 v132, v132
    v_exp_f32 v133, v133
    v_exp_f32 v134, v134
    v_exp_f32 v135, v135
    v_exp_f32 v136, v136
    v_exp_f32 v137, v137
    v_exp_f32 v138, v138
    v_exp_f32 v139, v139
    v_exp_f32 v140, v140
    v_exp_f32 v141, v141
    v_exp_f32 v142, v142
    v_exp_f32_e64 v143, v143
    v_cvt_pk_bf16_f32 v32, v128, v129
    v_cvt_pk_bf16_f32 v33, v130, v131
    v_cvt_pk_bf16_f32 v34, v132, v133
    v_cvt_pk_bf16_f32 v35, v134, v135
    v_cvt_pk_bf16_f32 v36, v136, v137
    v_cvt_pk_bf16_f32 v37, v138, v139
    v_cvt_pk_bf16_f32 v38, v140, v141
    v_cvt_pk_bf16_f32 v39, v142, v143
    s_waitcnt lgkmcnt(1)
    v_mfma_f32_32x32x16_bf16 v[176:191], a[72:75], v[32:35], v[176:191]
    s_waitcnt lgkmcnt(0)
    v_mfma_f32_32x32x16_bf16 v[176:191], a[76:79], v[36:39], v[176:191]
    s_nop 15
    v_rcp_f32 v72, v184
    s_add_u32 s54, s59, 0
    v_mul_f32 v176, v176, v72
    v_mul_f32 v177, v177, v72
    v_mul_f32 v178, v178, v72
    v_mul_f32 v179, v179, v72
    v_mul_f32 v180, v180, v72
    v_mul_f32 v181, v181, v72
    v_mul_f32 v182, v182, v72
    v_mul_f32_e64 v183, v183, v72
    v_cvt_pk_bf16_f32 v76, v176, v177
    v_cvt_pk_bf16_f32 v77, v178, v179
    v_cvt_pk_bf16_f32 v78, v180, v181
    v_cvt_pk_bf16_f32 v79, v182, v183
    buffer_store_dwordx4 v[76:79], v24, s[40:43], s54 offen sc1
    ds_read_b128 a[0:3], v60 offset:1056
    s_waitcnt lgkmcnt(0)
    v_mfma_f32_32x32x16_bf16 v[128:143], a[0:3], v[100:103], 0
    ds_read_b128 a[4:7], v60 offset:9504
    s_waitcnt lgkmcnt(0)
    v_mfma_f32_32x32x16_bf16 v[144:159], a[4:7], v[100:103], 0
    s_nop 11
    v_cndmask_b32 v128, v144, v128, s[64:65]
    v_cndmask_b32 v129, v145, v129, s[66:67]
    v_cndmask_b32 v130, v146, v130, s[68:69]
    v_cndmask_b32 v131, v147, v131, s[70:71]
    v_cndmask_b32 v132, v148, v132, s[72:73]
    v_cndmask_b32 v133, v149, v133, s[74:75]
    v_cndmask_b32 v134, v150, v134, s[76:77]
    v_cndmask_b32 v135, v151, v135, s[78:79]
    v_cndmask_b32 v136, v152, v136, s[80:81]
    v_cndmask_b32 v137, v153, v137, s[82:83]
    v_cndmask_b32 v138, v154, v138, s[84:85]
    v_cndmask_b32 v139, v155, v139, s[86:87]
    v_cndmask_b32 v140, v156, v140, s[88:89]
    v_cndmask_b32 v141, v157, v141, s[90:91]
    v_cndmask_b32 v142, v158, v142, s[92:93]
    v_cndmask_b32 v143, v159, v143, s[94:95]
    v_mov_b32 v64, v128
    v_max3_f32 v64, v64, v128, v129
    v_max3_f32 v64, v64, v130, v131
    v_max3_f32 v64, v64, v132, v133
    v_max3_f32 v64, v64, v134, v135
    v_max3_f32 v64, v64, v136, v137
    v_max3_f32 v64, v64, v138, v139
    v_max3_f32 v64, v64, v140, v141
    v_max3_f32 v64, v64, v142, v143
    ds_read_b128 a[0:3], v61 offset:1056
    s_waitcnt lgkmcnt(0)
    v_mfma_f32_32x32x16_bf16 v[128:143], a[0:3], v[100:103], 0
    s_nop 11
    v_max3_f32 v64, v64, v128, v129
    v_max3_f32 v64, v64, v130, v131
    v_max3_f32 v64, v64, v132, v133
    v_max3_f32 v64, v64, v134, v135
    v_max3_f32 v64, v64, v136, v137
    v_max3_f32 v64, v64, v138, v139
    v_max3_f32 v64, v64, v140, v141
    v_max3_f32 v64, v64, v142, v143
    ds_read_b128 a[0:3], v62 offset:1056
    s_waitcnt lgkmcnt(0)
    v_mfma_f32_32x32x16_bf16 v[128:143], a[0:3], v[100:103], 0
    s_nop 11
    v_max3_f32 v64, v64, v128, v129
    v_max3_f32 v64, v64, v130, v131
    v_max3_f32 v64, v64, v132, v133
    v_max3_f32 v64, v64, v134, v135
    v_max3_f32 v64, v64, v136, v137
    v_max3_f32 v64, v64, v138, v139
    v_max3_f32 v64, v64, v140, v141
    v_max3_f32 v64, v64, v142, v143
    ds_read_b128 a[0:3], v63 offset:1056
    s_waitcnt lgkmcnt(0)
    v_mfma_f32_32x32x16_bf16 v[128:143], a[0:3], v[100:103], 0
    s_nop 11
    v_max3_f32 v64, v64, v128, v129
    v_max3_f32 v64, v64, v130, v131
    v_max3_f32 v64, v64, v132, v133
    v_max3_f32 v64, v64, v134, v135
    v_max3_f32 v64, v64, v136, v137
    v_max3_f32 v64, v64, v138, v139
    v_max3_f32 v64, v64, v140, v141
    v_max3_f32 v64, v64, v142, v143
    ds_read_b128 a[0:3], v60 offset:5280
    s_waitcnt lgkmcnt(0)
    v_mfma_f32_32x32x16_bf16 v[128:143], a[0:3], v[100:103], 0
    s_nop 11
    v_max3_f32 v64, v64, v128, v129
    v_max3_f32 v64, v64, v130, v131
    v_max3_f32 v64, v64, v132, v133
    v_max3_f32 v64, v64, v134, v135
    v_max3_f32 v64, v64, v136, v137
    v_max3_f32 v64, v64, v138, v139
    v_max3_f32 v64, v64, v140, v141
    v_max3_f32 v64, v64, v142, v143
    ds_read_b128 a[0:3], v61 offset:5280
    s_waitcnt lgkmcnt(0)
    v_mfma_f32_32x32x16_bf16 v[128:143], a[0:3], v[100:103], 0
    s_nop 11
    v_max3_f32 v64, v64, v128, v129
    v_max3_f32 v64, v64, v130, v131
    v_max3_f32 v64, v64, v132, v133
    v_max3_f32 v64, v64, v134, v135
    v_max3_f32 v64, v64, v136, v137
    v_max3_f32 v64, v64, v138, v139
    v_max3_f32 v64, v64, v140, v141
    v_max3_f32 v64, v64, v142, v143
    ds_read_b128 a[0:3], v62 offset:5280
    s_waitcnt lgkmcnt(0)
    v_mfma_f32_32x32x16_bf16 v[128:143], a[0:3], v[100:103], 0
    s_nop 11
    v_max3_f32 v64, v64, v128, v129
    v_max3_f32 v64, v64, v130, v131
    v_max3_f32 v64, v64, v132, v133
    v_max3_f32 v64, v64, v134, v135
    v_max3_f32 v64, v64, v136, v137
    v_max3_f32 v64, v64, v138, v139
    v_max3_f32 v64, v64, v140, v141
    v_max3_f32 v64, v64, v142, v143
    ds_read_b128 a[0:3], v63 offset:5280
    s_waitcnt lgkmcnt(0)
    v_mfma_f32_32x32x16_bf16 v[128:143], a[0:3], v[100:103], 0
    s_nop 11
    v_max3_f32 v64, v64, v128, v129
    v_max3_f32 v64, v64, v130, v131
    v_max3_f32 v64, v64, v132, v133
    v_max3_f32 v64, v64, v134, v135
    v_max3_f32 v64, v64, v136, v137
    v_max3_f32 v64, v64, v138, v139
    v_max3_f32 v64, v64, v140, v141
    v_max3_f32 v64, v64, v142, v143
    v_mov_b32 v65, v64
    s_nop 1
    v_permlane32_swap_b32 v65, v64
    v_max_f32 v64, v64, v65
    v_sub_f32 v160, 0, v64
    v_sub_f32 v161, 0, v64
    v_sub_f32 v162, 0, v64
    v_sub_f32 v163, 0, v64
    v_sub_f32 v164, 0, v64
    v_sub_f32 v165, 0, v64
    v_sub_f32 v166, 0, v64
    v_sub_f32 v167, 0, v64
    v_sub_f32 v168, 0, v64
    v_sub_f32 v169, 0, v64
    v_sub_f32 v170, 0, v64
    v_sub_f32 v171, 0, v64
    v_sub_f32 v172, 0, v64
    v_sub_f32 v173, 0, v64
    v_sub_f32 v174, 0, v64
    v_sub_f32 v175, 0, v64
    ds_read_b128 a[0:3], v60 offset:1056
    s_waitcnt lgkmcnt(0)
    v_mfma_f32_32x32x16_bf16 v[128:143], a[0:3], v[100:103], v[160:175]
    ds_read_b128 a[4:7], v60 offset:9504
    s_waitcnt lgkmcnt(0)
    v_mfma_f32_32x32x16_bf16 v[144:159], a[4:7], v[100:103], v[160:175]
    s_nop 11
    v_cndmask_b32 v128, v144, v128, s[64:65]
    v_cndmask_b32 v129, v145, v129, s[66:67]
    v_cndmask_b32 v130, v146, v130, s[68:69]
    v_cndmask_b32 v131, v147, v131, s[70:71]
    v_cndmask_b32 v132, v148, v132, s[72:73]
    v_cndmask_b32 v133, v149, v133, s[74:75]
    v_cndmask_b32 v134, v150, v134, s[76:77]
    v_cndmask_b32 v135, v151, v135, s[78:79]
    v_cndmask_b32 v136, v152, v136, s[80:81]
    v_cndmask_b32 v137, v153, v137, s[82:83]
    v_cndmask_b32 v138, v154, v138, s[84:85]
    v_cndmask_b32 v139, v155, v139, s[86:87]
    v_cndmask_b32 v140, v156, v140, s[88:89]
    v_cndmask_b32 v141, v157, v141, s[90:91]
    v_cndmask_b32 v142, v158, v142, s[92:93]
    v_cndmask_b32 v143, v159, v143, s[94:95]
    ds_read_b128 a[72:75], v116 offset:2112
    ds_read_b128 a[76:79], v116 offset:3168
    ds_read_b128 a[80:83], v116 offset:10560
    ds_read_b128 a[84:87], v116 offset:11616
    v_exp_f32 v128, v128
    v_exp_f32 v129, v129
    v_exp_f32 v130, v130
    v_exp_f32 v131, v131
    v_exp_f32 v132, v132
    v_exp_f32 v133, v133
    v_exp_f32 v134, v134
    v_exp_f32 v135, v135
    v_exp_f32 v136, v136
    v_exp_f32 v137, v137
    v_exp_f32 v138, v138
    v_exp_f32 v139, v139
    v_exp_f32 v140, v140
    v_exp_f32 v141, v141
    v_exp_f32 v142, v142
    v_exp_f32_e64 v143, v143
    v_cvt_pk_bf16_f32 v32, v128, v129
    v_cvt_pk_bf16_f32 v33, v130, v131
    v_cvt_pk_bf16_f32 v34, v132, v133
    v_cvt_pk_bf16_f32 v35, v134, v135
    v_cvt_pk_bf16_f32 v36, v136, v137
    v_cvt_pk_bf16_f32 v37, v138, v139
    v_cvt_pk_bf16_f32 v38, v140, v141
    v_cvt_pk_bf16_f32 v39, v142, v143
    v_and_b32 v40, v32, v104
    v_and_b32 v41, v33, v105
    v_and_b32 v42, v34, v106
    v_and_b32 v43, v35, v107
    v_and_b32 v44, v36, v108
    v_and_b32 v45, v37, v109
    v_and_b32 v46, v38, v110
    v_and_b32 v47, v39, v111
    v_xor_b32 v32, v32, v40
    v_xor_b32 v33, v33, v41
    v_xor_b32 v34, v34, v42
    v_xor_b32 v35, v35, v43
    v_xor_b32 v36, v36, v44
    v_xor_b32 v37, v37, v45
    v_xor_b32 v38, v38, v46
    v_xor_b32_e64 v39, v39, v47
    s_waitcnt lgkmcnt(1)
    v_mfma_f32_32x32x16_bf16 v[176:191], a[80:83], v[32:35], 0
    s_waitcnt lgkmcnt(0)
    v_mfma_f32_32x32x16_bf16 v[176:191], a[84:87], v[36:39], v[176:191]
    v_mfma_f32_32x32x16_bf16 v[176:191], a[72:75], v[40:43], v[176:191]
    v_mfma_f32_32x32x16_bf16 v[176:191], a[76:79], v[44:47], v[176:191]
    s_nop 15
    ds_read_b128 a[0:3], v61 offset:1056
    s_waitcnt lgkmcnt(0)
    v_mfma_f32_32x32x16_bf16 v[128:143], a[0:3], v[100:103], v[160:175]
    ds_read_b128 a[72:75], v117 offset:2112
    ds_read_b128 a[76:79], v117 offset:3168
    s_nop 9
    v_exp_f32 v128, v128
    v_exp_f32 v129, v129
    v_exp_f32 v130, v130
    v_exp_f32 v131, v131
    v_exp_f32 v132, v132
    v_exp_f32 v133, v133
    v_exp_f32 v134, v134
    v_exp_f32 v135, v135
    v_exp_f32 v136, v136
    v_exp_f32 v137, v137
    v_exp_f32 v138, v138
    v_exp_f32 v139, v139
    v_exp_f32 v140, v140
    v_exp_f32 v141, v141
    v_exp_f32 v142, v142
    v_exp_f32 v143, v143
    v_cvt_pk_bf16_f32 v32, v128, v129
    v_cvt_pk_bf16_f32 v33, v130, v131
    v_cvt_pk_bf16_f32 v34, v132, v133
    v_cvt_pk_bf16_f32 v35, v134, v135
    v_cvt_pk_bf16_f32 v36, v136, v137
    v_cvt_pk_bf16_f32 v37, v138, v139
    v_cvt_pk_bf16_f32 v38, v140, v141
    v_cvt_pk_bf16_f32 v39, v142, v143
    s_waitcnt lgkmcnt(1)
    v_mfma_f32_32x32x16_bf16 v[176:191], a[72:75], v[32:35], v[176:191]
    s_waitcnt lgkmcnt(0)
    v_mfma_f32_32x32x16_bf16 v[176:191], a[76:79], v[36:39], v[176:191]
    s_nop 15
    ds_read_b128 a[0:3], v62 offset:1056
    s_waitcnt lgkmcnt(0)
    v_mfma_f32_32x32x16_bf16 v[128:143], a[0:3], v[100:103], v[160:175]
    ds_read_b128 a[72:75], v118 offset:2112
    ds_read_b128 a[76:79], v118 offset:3168
    s_nop 9
    v_exp_f32 v128, v128
    v_exp_f32 v129, v129
    v_exp_f32 v130, v130
    v_exp_f32 v131, v131
    v_exp_f32 v132, v132
    v_exp_f32 v133, v133
    v_exp_f32 v134, v134
    v_exp_f32 v135, v135
    v_exp_f32 v136, v136
    v_exp_f32 v137, v137
    v_exp_f32 v138, v138
    v_exp_f32 v139, v139
    v_exp_f32 v140, v140
    v_exp_f32 v141, v141
    v_exp_f32 v142, v142
    v_exp_f32_e64 v143, v143
    v_cvt_pk_bf16_f32 v32, v128, v129
    v_cvt_pk_bf16_f32 v33, v130, v131
    v_cvt_pk_bf16_f32 v34, v132, v133
    v_cvt_pk_bf16_f32 v35, v134, v135
    v_cvt_pk_bf16_f32 v36, v136, v137
    v_cvt_pk_bf16_f32 v37, v138, v139
    v_cvt_pk_bf16_f32 v38, v140, v141
    v_cvt_pk_bf16_f32 v39, v142, v143
    s_waitcnt lgkmcnt(1)
    v_mfma_f32_32x32x16_bf16 v[176:191], a[72:75], v[32:35], v[176:191]
    s_waitcnt lgkmcnt(0)
    v_mfma_f32_32x32x16_bf16 v[176:191], a[76:79], v[36:39], v[176:191]
    s_nop 15
    ds_read_b128 a[0:3], v63 offset:1056
    s_waitcnt lgkmcnt(0)
    v_mfma_f32_32x32x16_bf16 v[128:143], a[0:3], v[100:103], v[160:175]
    ds_read_b128 a[72:75], v119 offset:2112
    ds_read_b128 a[76:79], v119 offset:3168
    s_nop 9
    v_exp_f32 v128, v128
    v_exp_f32 v129, v129
    v_exp_f32 v130, v130
    v_exp_f32 v131, v131
    v_exp_f32 v132, v132
    v_exp_f32 v133, v133
    v_exp_f32 v134, v134
    v_exp_f32 v135, v135
    v_exp_f32 v136, v136
    v_exp_f32 v137, v137
    v_exp_f32 v138, v138
    v_exp_f32 v139, v139
    v_exp_f32 v140, v140
    v_exp_f32 v141, v141
    v_exp_f32 v142, v142
    v_exp_f32_e64 v143, v143
    v_cvt_pk_bf16_f32 v32, v128, v129
    v_cvt_pk_bf16_f32 v33, v130, v131
    v_cvt_pk_bf16_f32 v34, v132, v133
    v_cvt_pk_bf16_f32 v35, v134, v135
    v_cvt_pk_bf16_f32 v36, v136, v137
    v_cvt_pk_bf16_f32 v37, v138, v139
    v_cvt_pk_bf16_f32 v38, v140, v141
    v_cvt_pk_bf16_f32 v39, v142, v143
    s_waitcnt lgkmcnt(1)
    v_mfma_f32_32x32x16_bf16 v[176:191], a[72:75], v[32:35], v[176:191]
    s_waitcnt lgkmcnt(0)
    v_mfma_f32_32x32x16_bf16 v[176:191], a[76:79], v[36:39], v[176:191]
    s_nop 15
    ds_read_b128 a[0:3], v60 offset:5280
    s_waitcnt lgkmcnt(0)
    v_mfma_f32_32x32x16_bf16 v[128:143], a[0:3], v[100:103], v[160:175]
    ds_read_b128 a[72:75], v116 offset:6336
    ds_read_b128 a[76:79], v116 offset:7392
    s_nop 9
    v_exp_f32 v128, v128
    v_exp_f32 v129, v129
    v_exp_f32 v130, v130
    v_exp_f32 v131, v131
    v_exp_f32 v132, v132
    v_exp_f32 v133, v133
    v_exp_f32 v134, v134
    v_exp_f32 v135, v135
    v_exp_f32 v136, v136
    v_exp_f32 v137, v137
    v_exp_f32 v138, v138
    v_exp_f32 v139, v139
    v_exp_f32 v140, v140
    v_exp_f32 v141, v141
    v_exp_f32 v142, v142
    v_exp_f32_e64 v143, v143
    v_cvt_pk_bf16_f32 v32, v128, v129
    v_cvt_pk_bf16_f32 v33, v130, v131
    v_cvt_pk_bf16_f32 v34, v132, v133
    v_cvt_pk_bf16_f32 v35, v134, v135
    v_cvt_pk_bf16_f32 v36, v136, v137
    v_cvt_pk_bf16_f32 v37, v138, v139
    v_cvt_pk_bf16_f32 v38, v140, v141
    v_cvt_pk_bf16_f32 v39, v142, v143
    s_waitcnt lgkmcnt(1)
    v_mfma_f32_32x32x16_bf16 v[176:191], a[72:75], v[32:35], v[176:191]
    s_waitcnt lgkmcnt(0)
    v_mfma_f32_32x32x16_bf16 v[176:191], a[76:79], v[36:39], v[176:191]
    s_nop 15
    ds_read_b128 a[0:3], v61 offset:5280
    s_waitcnt lgkmcnt(0)
    v_mfma_f32_32x32x16_bf16 v[128:143], a[0:3], v[100:103], v[160:175]
    ds_read_b128 a[72:75], v117 offset:6336
    ds_read_b128 a[76:79], v117 offset:7392
    s_nop 9
    v_exp_f32 v128, v128
    v_exp_f32 v129, v129
    v_exp_f32 v130, v130
    v_exp_f32 v131, v131
    v_exp_f32 v132, v132
    v_exp_f32 v133, v133
    v_exp_f32 v134, v134
    v_exp_f32 v135, v135
    v_exp_f32 v136, v136
    v_exp_f32 v137, v137
    v_exp_f32 v138, v138
    v_exp_f32 v139, v139
    v_exp_f32 v140, v140
    v_exp_f32 v141, v141
    v_exp_f32 v142, v142
    v_exp_f32_e64 v143, v143
    v_cvt_pk_bf16_f32 v32, v128, v129
    v_cvt_pk_bf16_f32 v33, v130, v131
    v_cvt_pk_bf16_f32 v34, v132, v133
    v_cvt_pk_bf16_f32 v35, v134, v135
    v_cvt_pk_bf16_f32 v36, v136, v137
    v_cvt_pk_bf16_f32 v37, v138, v139
    v_cvt_pk_bf16_f32 v38, v140, v141
    v_cvt_pk_bf16_f32 v39, v142, v143
    s_waitcnt lgkmcnt(1)
    v_mfma_f32_32x32x16_bf16 v[176:191], a[72:75], v[32:35], v[176:191]
    s_waitcnt lgkmcnt(0)
    v_mfma_f32_32x32x16_bf16 v[176:191], a[76:79], v[36:39], v[176:191]
    s_nop 15
    ds_read_b128 a[0:3], v62 offset:5280
    s_waitcnt lgkmcnt(0)
    v_mfma_f32_32x32x16_bf16 v[128:143], a[0:3], v[100:103], v[160:175]
    ds_read_b128 a[72:75], v118 offset:6336
    ds_read_b128 a[76:79], v118 offset:7392
    s_nop 9
    v_exp_f32 v128, v128
    v_exp_f32 v129, v129
    v_exp_f32 v130, v130
    v_exp_f32 v131, v131
    v_exp_f32 v132, v132
    v_exp_f32 v133, v133
    v_exp_f32 v134, v134
    v_exp_f32 v135, v135
    v_exp_f32 v136, v136
    v_exp_f32 v137, v137
    v_exp_f32 v138, v138
    v_exp_f32 v139, v139
    v_exp_f32 v140, v140
    v_exp_f32 v141, v141
    v_exp_f32 v142, v142
    v_exp_f32_e64 v143, v143
    v_cvt_pk_bf16_f32 v32, v128, v129
    v_cvt_pk_bf16_f32 v33, v130, v131
    v_cvt_pk_bf16_f32 v34, v132, v133
    v_cvt_pk_bf16_f32 v35, v134, v135
    v_cvt_pk_bf16_f32 v36, v136, v137
    v_cvt_pk_bf16_f32 v37, v138, v139
    v_cvt_pk_bf16_f32 v38, v140, v141
    v_cvt_pk_bf16_f32 v39, v142, v143
    s_waitcnt lgkmcnt(1)
    v_mfma_f32_32x32x16_bf16 v[176:191], a[72:75], v[32:35], v[176:191]
    s_waitcnt lgkmcnt(0)
    v_mfma_f32_32x32x16_bf16 v[176:191], a[76:79], v[36:39], v[176:191]
    s_nop 15
    ds_read_b128 a[0:3], v63 offset:5280
    s_waitcnt lgkmcnt(0)
    v_mfma_f32_32x32x16_bf16 v[128:143], a[0:3], v[100:103], v[160:175]
    ds_read_b128 a[72:75], v119 offset:6336
    ds_read_b128 a[76:79], v119 offset:7392
    s_nop 9
    v_exp_f32 v128, v128
    v_exp_f32 v129, v129
    v_exp_f32 v130, v130
    v_exp_f32 v131, v131
    v_exp_f32 v132, v132
    v_exp_f32 v133, v133
    v_exp_f32 v134, v134
    v_exp_f32 v135, v135
    v_exp_f32 v136, v136
    v_exp_f32 v137, v137
    v_exp_f32 v138, v138
    v_exp_f32 v139, v139
    v_exp_f32 v140, v140
    v_exp_f32 v141, v141
    v_exp_f32 v142, v142
    v_exp_f32_e64 v143, v143
    v_cvt_pk_bf16_f32 v32, v128, v129
    v_cvt_pk_bf16_f32 v33, v130, v131
    v_cvt_pk_bf16_f32 v34, v132, v133
    v_cvt_pk_bf16_f32 v35, v134, v135
    v_cvt_pk_bf16_f32 v36, v136, v137
    v_cvt_pk_bf16_f32 v37, v138, v139
    v_cvt_pk_bf16_f32 v38, v140, v141
    v_cvt_pk_bf16_f32 v39, v142, v143
    s_waitcnt lgkmcnt(1)
    v_mfma_f32_32x32x16_bf16 v[176:191], a[72:75], v[32:35], v[176:191]
    s_waitcnt lgkmcnt(0)
    v_mfma_f32_32x32x16_bf16 v[176:191], a[76:79], v[36:39], v[176:191]
    s_nop 15
    v_rcp_f32 v72, v184
    s_add_u32 s54, s59, 4096
    v_mul_f32 v176, v176, v72
    v_mul_f32 v177, v177, v72
    v_mul_f32 v178, v178, v72
    v_mul_f32 v179, v179, v72
    v_mul_f32 v180, v180, v72
    v_mul_f32 v181, v181, v72
    v_mul_f32 v182, v182, v72
    v_mul_f32 v183, v183, v72
    v_cvt_pk_bf16_f32 v76, v176, v177
    v_cvt_pk_bf16_f32 v77, v178, v179
    v_cvt_pk_bf16_f32 v78, v180, v181
    v_cvt_pk_bf16_f32 v79, v182, v183
    buffer_store_dwordx4 v[76:79], v24, s[40:43], s54 offen sc1
    s_waitcnt vmcnt(0) lgkmcnt(0)
    s_nop 15
    s_branch L_exact_done
Lpoll_7:
    s_mov_b32 s63, 0
Lpoll_7_l:
    buffer_load_dwordx2 v[8:9], v13, s[28:31], s10 offen sc1
    s_waitcnt vmcnt(0)
    v_cmp_ne_u64 vcc, s[52:53], v[8:9]
    s_add_u32 s63, s63, 1
    s_nop 0
    s_cmp_eq_u64 vcc, 0
    s_cbranch_scc1 Lpollb_8
    s_sleep 1
    s_cmp_lt_u32 s63, 0x40000
    s_cbranch_scc1 Lpoll_7_l
    s_branch Lpollb_8
s_endpgm
L_code_end:
.section .rodata,"a"
.p2align 6
.amdhsa_kernel gated_mix__sliding_block__mixer_channel_mlp__prompt_kernel
  .amdhsa_next_free_vgpr 512
  .amdhsa_next_free_sgpr 102
  .amdhsa_accum_offset 256
  .amdhsa_group_segment_fixed_size 0
  .amdhsa_kernarg_size 96
  .amdhsa_user_sgpr_count 2
  .amdhsa_user_sgpr_kernarg_segment_ptr 1
  .amdhsa_system_sgpr_workgroup_id_x 1
.end_amdhsa_kernel
```
